```python
import torch

def _softmax(x, axis=-1):
    return torch.softmax(x, dim=axis)

def _gelu(x):
    return torch.nn.functional.gelu(x, approximate='tanh')

def _silu(x):
    return torch.nn.functional.silu(x)

def _sigmoid(x):
    return torch.sigmoid(x)

def _layernorm(x, axis=-1, eps=1e-05):
    m = x.mean(dim=axis, keepdim=True)
    v = x.var(dim=axis, keepdim=True, unbiased=False)
    return (x - m) / torch.sqrt(v + eps)

def _scatter_add(tgt, idx, src, axis=0):
    return tgt.clone().index_add_(axis, idx, src)

def _segment_sum(src, seg, n):
    out = torch.zeros((n,) + src.shape[1:], dtype=src.dtype)
    return out.index_add_(0, seg, src)

def _pad(x, pw):
    flat = tuple((v for pair in reversed(pw) for v in pair))
    return torch.nn.functional.pad(x, flat)
kernel_name = 'adaLN_cond__mha_block__glu_gated_swiglu__prompt'

def setup_inputs():

    _w = lambda a: (lambda t: t.to(torch.bfloat16) if t.is_floating_point() else t)(torch.as_tensor(a))

    def _A_setup():
        B, S, D, H = (1, 2048, 576, 32)
        return {'x': _w((lambda *s: torch.randn(*s, dtype=torch.bfloat16) * 0.05)(B, S, D)), 'wqkv': _w((lambda *s: torch.randn(*s, dtype=torch.bfloat16) * 0.05)(D, 3 * D)), 'wo': _w((lambda *s: torch.randn(*s, dtype=torch.bfloat16) * 0.05)(D, D))}
    _A_in = _A_setup()

    def _B_setup():
        B, S, D, F = (1, 2048, 576, 4608)
        return {'x': _w((lambda *s: torch.randn(*s, dtype=torch.bfloat16) * 0.05)(B, S, D)), 'w1': _w((lambda *s: torch.randn(*s, dtype=torch.bfloat16) * 0.8)(D, F) * (2.0 / D) ** 0.5), 'w3': _w((lambda *s: torch.randn(*s, dtype=torch.bfloat16) * 0.8)(D, F) * (2.0 / D) ** 0.5), 'w2': _w((lambda *s: torch.randn(*s, dtype=torch.bfloat16) * 0.8)(F, D) * (2.0 / F) ** 0.5)}
    _B_in = _B_setup()
    return {'A_x': _A_in['x'], 'A_wqkv': _A_in['wqkv'], 'A_wo': _A_in['wo'], 'B_x': _B_in['x'], 'B_w1': _B_in['w1'], 'B_w3': _B_in['w3'], 'B_w2': _B_in['w2'], 'c': _w((lambda *s: torch.randn(*s, dtype=torch.bfloat16) * 0.2)(1, 576) * 8.0), 'w_mod': _w((lambda *s: torch.randn(*s, dtype=torch.bfloat16) * 0.2)(576, 6 * 576) * 576 ** (-0.5) * 8.0)}

def reference(A_x, A_wqkv, A_wo, B_x, B_w1, B_w3, B_w2, c, w_mod):

    def _A_ref(x, wqkv, wo):
        B, S, D = x.shape
        H = 32
        Dh = D // H
        qkv = (lambda x, *d: x.permute(*d))((x @ wqkv).reshape(B, S, 3, H, Dh), 2, 0, 3, 1, 4)
        q, k, v = (qkv[0], qkv[1], qkv[2])
        scores = torch.einsum('bhqd,bhkd->bhqk', q, k) * Dh ** (-0.5)
        p = _softmax(scores, axis=-1)
        o = torch.einsum('bhqk,bhkd->bhqd', p, v)
        return (lambda x, *d: x.permute(*d))(o, 0, 2, 1, 3).reshape(B, S, D) @ wo

    def _B_ref(x, w1, w3, w2):
        gate = torch.einsum('bsd,df->bsf', x, w1)
        up = torch.einsum('bsd,df->bsf', x, w3)
        h = _silu(gate) * up
        out = torch.einsum('bsf,fd->bsd', h, w2)
        return out
    x = A_x
    mod = (_silu(c) @ w_mod).reshape(c.shape[0], 6, 1, -1)
    sa, ca, ga, sb, cb, gb = (mod[:, 0].clone(), mod[:, 1].clone(), mod[:, 2].clone(), mod[:, 3].clone(), mod[:, 4].clone(), mod[:, 5].clone())
    h = _layernorm(x, axis=-1) * (1 + ca) + sa
    x = x + ga * _A_ref(h, A_wqkv, A_wo)
    h = _layernorm(x, axis=-1) * (1 + cb) + sb
    x = x + gb * _B_ref(h, B_w1, B_w3, B_w2)
    return x
```

```asm
; @launch kernel=kf_front_kernel grid=(256,1,1) block=(512,1,1) lds=106496
; @launch kernel=k3_attn_kernel grid=(256,1,1) block=(768,1,1) lds=159808
.amdgcn_target "amdgcn-amd-amdhsa--gfx950"
.text
.globl kf_front_kernel
.p2align 8
.type kf_front_kernel,@function
kf_front_kernel:
s_cmp_ge_u32 s2, 256
s_cbranch_scc1 k2_exit
v_lshrrev_b32 v1, 6, v0
s_nop 0
v_readfirstlane_b32 s22, v1
s_nop 0
s_lshr_b32 s46, s22, 2
s_mov_b32 s47, s22
s_and_b32 s23, s2, 1
s_cmp_ge_u32 s2, 192
s_cselect_b32 s23, s23, 0
s_cmp_lg_u32 s23, 0
s_cbranch_scc1 kf_side
s_cmp_lt_u32 s2, 36
s_cbranch_scc1 kf_mod01
s_cmp_lt_u32 s2, 100
s_cbranch_scc1 kf_xn
s_cmp_lt_u32 s2, 154
s_cbranch_scc1 kf_wqkv
s_branch kf_task_done
kf_mod01:
s_cmp_eq_u32 s46, 0
s_cbranch_scc1 kf_mod01_go
s_barrier
s_barrier
s_branch kf_task_done
kf_mod01_go:
s_mov_b32 s44, s2
s_mov_b32 s45, 0
s_load_dwordx2 s[4:5], s[0:1], 64
s_load_dwordx2 s[6:7], s[0:1], 56
s_load_dwordx2 s[20:21], s[0:1], 88
v_and_b32 v30, 255, v0
v_and_b32 v1, 3, v30
v_lshrrev_b32 v2, 2, v30
s_waitcnt lgkmcnt(0)
s_mov_b32 s8, s4
s_mov_b32 s9, s5
s_mov_b32 s10, 0x3cc000
s_mov_b32 s11, 0x00020000
s_mov_b32 s12, s6
s_mov_b32 s13, s7
s_mov_b32 s14, 0x480
s_mov_b32 s15, 0x00020000
s_mov_b32 s16, s20
s_mov_b32 s17, s21
s_mov_b32 s18, 0x3600
s_mov_b32 s19, 0x00020000
v_lshlrev_b32 v3, 1, v30
buffer_load_ushort v4, v3, s[12:15], 0 offen
buffer_load_ushort v5, v3, s[12:15], 0 offen offset:512
buffer_load_ushort v6, v3, s[12:15], 0 offen offset:1024
v_mul_u32_u24 v7, 6912, v2
v_lshl_add_u32 v7, v1, 4, v7
s_mul_i32 s22, s44, 64
buffer_load_dwordx4 v[32:35], v7, s[8:11], s22 offen
s_add_u32 s22, s22, 442368
buffer_load_dwordx4 v[36:39], v7, s[8:11], s22 offen
s_add_u32 s22, s22, 442368
buffer_load_dwordx4 v[40:43], v7, s[8:11], s22 offen
s_add_u32 s22, s22, 442368
buffer_load_dwordx4 v[44:47], v7, s[8:11], s22 offen
s_add_u32 s22, s22, 442368
buffer_load_dwordx4 v[48:51], v7, s[8:11], s22 offen
s_add_u32 s22, s22, 442368
buffer_load_dwordx4 v[52:55], v7, s[8:11], s22 offen
s_add_u32 s22, s22, 442368
buffer_load_dwordx4 v[56:59], v7, s[8:11], s22 offen
s_add_u32 s22, s22, 442368
buffer_load_dwordx4 v[60:63], v7, s[8:11], s22 offen
s_add_u32 s22, s22, 442368
buffer_load_dwordx4 v[64:67], v7, s[8:11], s22 offen
v_lshlrev_b32 v9, 2, v30
v_add_u32 v9, s45, v9
s_waitcnt vmcnt(9)
v_lshlrev_b32 v4, 16, v4
v_mul_f32 v8, 0x3fb8aa3b, v4
v_exp_f32 v8, -v8
s_nop 0
v_add_f32 v8, 1.0, v8
v_rcp_f32 v8, v8
s_nop 0
v_mul_f32 v8, v8, v4
v_cvt_pk_bf16_f32 v8, v8, v8
v_and_b32 v8, 0xffff0000, v8
ds_write_b32 v9, v8 offset:0
v_lshlrev_b32 v5, 16, v5
v_mul_f32 v8, 0x3fb8aa3b, v5
v_exp_f32 v8, -v8
s_nop 0
v_add_f32 v8, 1.0, v8
v_rcp_f32 v8, v8
s_nop 0
v_mul_f32 v8, v8, v5
v_cvt_pk_bf16_f32 v8, v8, v8
v_and_b32 v8, 0xffff0000, v8
ds_write_b32 v9, v8 offset:1024
v_lshlrev_b32 v6, 16, v6
v_mul_f32 v8, 0x3fb8aa3b, v6
v_exp_f32 v8, -v8
s_nop 0
v_add_f32 v8, 1.0, v8
v_rcp_f32 v8, v8
s_nop 0
v_mul_f32 v8, v8, v6
v_cvt_pk_bf16_f32 v8, v8, v8
v_and_b32 v8, 0xffff0000, v8
ds_write_b32 v9, v8 offset:2048
s_waitcnt lgkmcnt(0)
s_barrier
v_lshlrev_b32 v9, 2, v2
v_add_u32 v9, s45, v9
ds_read_b32 v10, v9 offset:0
ds_read_b32 v11, v9 offset:256
ds_read_b32 v12, v9 offset:512
ds_read_b32 v13, v9 offset:768
ds_read_b32 v14, v9 offset:1024
ds_read_b32 v15, v9 offset:1280
ds_read_b32 v16, v9 offset:1536
ds_read_b32 v17, v9 offset:1792
ds_read_b32 v18, v9 offset:2048
v_mov_b32 v104, 0
v_mov_b32 v105, 0
v_mov_b32 v106, 0
v_mov_b32 v107, 0
v_mov_b32 v108, 0
v_mov_b32 v109, 0
v_mov_b32 v110, 0
v_mov_b32 v111, 0
s_waitcnt lgkmcnt(0)
s_waitcnt vmcnt(8)
v_lshrrev_b32 v28, 16, v10
v_dot2_f32_bf16 v104, v32, v28, v104
v_dot2_f32_bf16 v105, v32, v10, v105
v_dot2_f32_bf16 v106, v33, v28, v106
v_dot2_f32_bf16 v107, v33, v10, v107
v_dot2_f32_bf16 v108, v34, v28, v108
v_dot2_f32_bf16 v109, v34, v10, v109
v_dot2_f32_bf16 v110, v35, v28, v110
v_dot2_f32_bf16 v111, v35, v10, v111
s_waitcnt vmcnt(7)
v_lshrrev_b32 v28, 16, v11
v_dot2_f32_bf16 v104, v36, v28, v104
v_dot2_f32_bf16 v105, v36, v11, v105
v_dot2_f32_bf16 v106, v37, v28, v106
v_dot2_f32_bf16 v107, v37, v11, v107
v_dot2_f32_bf16 v108, v38, v28, v108
v_dot2_f32_bf16 v109, v38, v11, v109
v_dot2_f32_bf16 v110, v39, v28, v110
v_dot2_f32_bf16 v111, v39, v11, v111
s_waitcnt vmcnt(6)
v_lshrrev_b32 v28, 16, v12
v_dot2_f32_bf16 v104, v40, v28, v104
v_dot2_f32_bf16 v105, v40, v12, v105
v_dot2_f32_bf16 v106, v41, v28, v106
v_dot2_f32_bf16 v107, v41, v12, v107
v_dot2_f32_bf16 v108, v42, v28, v108
v_dot2_f32_bf16 v109, v42, v12, v109
v_dot2_f32_bf16 v110, v43, v28, v110
v_dot2_f32_bf16 v111, v43, v12, v111
s_waitcnt vmcnt(5)
v_lshrrev_b32 v28, 16, v13
v_dot2_f32_bf16 v104, v44, v28, v104
v_dot2_f32_bf16 v105, v44, v13, v105
v_dot2_f32_bf16 v106, v45, v28, v106
v_dot2_f32_bf16 v107, v45, v13, v107
v_dot2_f32_bf16 v108, v46, v28, v108
v_dot2_f32_bf16 v109, v46, v13, v109
v_dot2_f32_bf16 v110, v47, v28, v110
v_dot2_f32_bf16 v111, v47, v13, v111
s_waitcnt vmcnt(4)
v_lshrrev_b32 v28, 16, v14
v_dot2_f32_bf16 v104, v48, v28, v104
v_dot2_f32_bf16 v105, v48, v14, v105
v_dot2_f32_bf16 v106, v49, v28, v106
v_dot2_f32_bf16 v107, v49, v14, v107
v_dot2_f32_bf16 v108, v50, v28, v108
v_dot2_f32_bf16 v109, v50, v14, v109
v_dot2_f32_bf16 v110, v51, v28, v110
v_dot2_f32_bf16 v111, v51, v14, v111
s_waitcnt vmcnt(3)
v_lshrrev_b32 v28, 16, v15
v_dot2_f32_bf16 v104, v52, v28, v104
v_dot2_f32_bf16 v105, v52, v15, v105
v_dot2_f32_bf16 v106, v53, v28, v106
v_dot2_f32_bf16 v107, v53, v15, v107
v_dot2_f32_bf16 v108, v54, v28, v108
v_dot2_f32_bf16 v109, v54, v15, v109
v_dot2_f32_bf16 v110, v55, v28, v110
v_dot2_f32_bf16 v111, v55, v15, v111
s_waitcnt vmcnt(2)
v_lshrrev_b32 v28, 16, v16
v_dot2_f32_bf16 v104, v56, v28, v104
v_dot2_f32_bf16 v105, v56, v16, v105
v_dot2_f32_bf16 v106, v57, v28, v106
v_dot2_f32_bf16 v107, v57, v16, v107
v_dot2_f32_bf16 v108, v58, v28, v108
v_dot2_f32_bf16 v109, v58, v16, v109
v_dot2_f32_bf16 v110, v59, v28, v110
v_dot2_f32_bf16 v111, v59, v16, v111
s_waitcnt vmcnt(1)
v_lshrrev_b32 v28, 16, v17
v_dot2_f32_bf16 v104, v60, v28, v104
v_dot2_f32_bf16 v105, v60, v17, v105
v_dot2_f32_bf16 v106, v61, v28, v106
v_dot2_f32_bf16 v107, v61, v17, v107
v_dot2_f32_bf16 v108, v62, v28, v108
v_dot2_f32_bf16 v109, v62, v17, v109
v_dot2_f32_bf16 v110, v63, v28, v110
v_dot2_f32_bf16 v111, v63, v17, v111
s_waitcnt vmcnt(0)
v_lshrrev_b32 v28, 16, v18
v_dot2_f32_bf16 v104, v64, v28, v104
v_dot2_f32_bf16 v105, v64, v18, v105
v_dot2_f32_bf16 v106, v65, v28, v106
v_dot2_f32_bf16 v107, v65, v18, v107
v_dot2_f32_bf16 v108, v66, v28, v108
v_dot2_f32_bf16 v109, v66, v18, v109
v_dot2_f32_bf16 v110, v67, v28, v110
v_dot2_f32_bf16 v111, v67, v18, v111
v_mul_u32_u24 v9, 128, v2
v_lshl_add_u32 v9, v1, 5, v9
v_add_u32 v9, s45, v9
ds_write_b128 v9, v[104:107] offset:4096
ds_write_b128 v9, v[108:111] offset:4112
s_waitcnt lgkmcnt(0)
s_barrier
v_cmp_gt_u32 vcc, 64, v30
s_nop 0
s_and_saveexec_b64 s[24:25], vcc
s_cbranch_execz kfa_mod_end
v_and_b32 v10, 31, v30
v_lshlrev_b32 v9, 2, v10
v_add_u32 v3, s45, v9
v_lshrrev_b32 v11, 5, v30
v_mul_u32_u24 v11, 4096, v11
v_add_u32 v3, v3, v11
ds_read_b32 v32, v3 offset:4096
ds_read_b32 v33, v3 offset:4224
ds_read_b32 v34, v3 offset:4352
ds_read_b32 v35, v3 offset:4480
ds_read_b32 v36, v3 offset:4608
ds_read_b32 v37, v3 offset:4736
ds_read_b32 v38, v3 offset:4864
ds_read_b32 v39, v3 offset:4992
ds_read_b32 v40, v3 offset:5120
ds_read_b32 v41, v3 offset:5248
ds_read_b32 v42, v3 offset:5376
ds_read_b32 v43, v3 offset:5504
ds_read_b32 v44, v3 offset:5632
ds_read_b32 v45, v3 offset:5760
ds_read_b32 v46, v3 offset:5888
ds_read_b32 v47, v3 offset:6016
ds_read_b32 v48, v3 offset:6144
ds_read_b32 v49, v3 offset:6272
ds_read_b32 v50, v3 offset:6400
ds_read_b32 v51, v3 offset:6528
ds_read_b32 v52, v3 offset:6656
ds_read_b32 v53, v3 offset:6784
ds_read_b32 v54, v3 offset:6912
ds_read_b32 v55, v3 offset:7040
ds_read_b32 v56, v3 offset:7168
ds_read_b32 v57, v3 offset:7296
ds_read_b32 v58, v3 offset:7424
ds_read_b32 v59, v3 offset:7552
ds_read_b32 v60, v3 offset:7680
ds_read_b32 v61, v3 offset:7808
ds_read_b32 v62, v3 offset:7936
ds_read_b32 v63, v3 offset:8064
s_waitcnt lgkmcnt(0)
v_add_f32 v32, v32, v48
v_add_f32 v33, v33, v49
v_add_f32 v34, v34, v50
v_add_f32 v35, v35, v51
v_add_f32 v36, v36, v52
v_add_f32 v37, v37, v53
v_add_f32 v38, v38, v54
v_add_f32 v39, v39, v55
v_add_f32 v40, v40, v56
v_add_f32 v41, v41, v57
v_add_f32 v42, v42, v58
v_add_f32 v43, v43, v59
v_add_f32 v44, v44, v60
v_add_f32 v45, v45, v61
v_add_f32 v46, v46, v62
v_add_f32 v47, v47, v63
v_add_f32 v32, v32, v40
v_add_f32 v33, v33, v41
v_add_f32 v34, v34, v42
v_add_f32 v35, v35, v43
v_add_f32 v36, v36, v44
v_add_f32 v37, v37, v45
v_add_f32 v38, v38, v46
v_add_f32 v39, v39, v47
v_add_f32 v32, v32, v36
v_add_f32 v33, v33, v37
v_add_f32 v34, v34, v38
v_add_f32 v35, v35, v39
v_add_f32 v32, v32, v34
v_add_f32 v33, v33, v35
v_add_f32 v32, v32, v33
v_mov_b32 v33, v32
s_nop 1
v_permlane32_swap_b32 v32, v33
v_add_f32 v32, v32, v33
v_cvt_pk_bf16_f32 v32, v32, v32
v_and_b32 v32, 0xffff0000, v32
s_mul_hi_u32 s22, s44, 0xe38e38f
s_cmp_eq_u32 s22, 1
s_cselect_b32 s23, 1, 0
s_cmp_eq_u32 s22, 4
s_cselect_b32 s23, 1, s23
s_cmp_eq_u32 s23, 0
s_cbranch_scc1 kfa_noone
v_add_f32 v32, 1.0, v32
v_cvt_pk_bf16_f32 v32, v32, v32
v_and_b32 v32, 0xffff0000, v32
kfa_noone:
s_mul_i32 s22, s44, 128
buffer_store_dword v32, v9, s[16:19], s22 offen sc0 sc1
kfa_mod_end:
s_mov_b64 exec, -1
s_branch kf_task_done
kf_xn:
s_cmp_eq_u32 s46, 0
s_cbranch_scc1 kf_xn_go
s_barrier
s_branch kf_task_done
kf_xn_go:
s_sub_u32 s23, s2, 36
s_load_dwordx2 s[4:5], s[0:1], 0
s_load_dwordx2 s[20:21], s[0:1], 88
v_and_b32 v1, 63, v0
v_and_b32 v2, 15, v1
v_lshrrev_b32 v3, 4, v1
v_lshlrev_b32 v4, 4, v1
s_lshr_b32 s26, s22, 1
s_and_b32 s26, s26, 1
s_and_b32 s27, s22, 1
v_mul_u32_u24 v5, 1152, v2
v_lshl_add_u32 v5, v3, 4, v5
s_mul_i32 s28, s23, 36864
s_mul_i32 s29, s26, 18432
s_add_u32 s28, s28, s29
s_mul_i32 s29, s27, 576
s_add_u32 s28, s28, s29
s_waitcnt lgkmcnt(0)
s_mov_b32 s8, s4
s_mov_b32 s9, s5
s_mov_b32 s10, 0x240000
s_mov_b32 s11, 0x00020000
s_add_u32 s12, s20, 0x3400000
s_addc_u32 s13, s21, 0
s_mov_b32 s14, 0x240000
s_mov_b32 s15, 0x00020000
buffer_load_dwordx4 v[16:19], v5, s[8:11], s28 offen offset:0
buffer_load_dwordx4 v[20:23], v5, s[8:11], s28 offen offset:64
buffer_load_dwordx4 v[24:27], v5, s[8:11], s28 offen offset:128
buffer_load_dwordx4 v[28:31], v5, s[8:11], s28 offen offset:192
buffer_load_dwordx4 v[32:35], v5, s[8:11], s28 offen offset:256
buffer_load_dwordx4 v[36:39], v5, s[8:11], s28 offen offset:320
buffer_load_dwordx4 v[40:43], v5, s[8:11], s28 offen offset:384
buffer_load_dwordx4 v[44:47], v5, s[8:11], s28 offen offset:448
buffer_load_dwordx4 v[48:51], v5, s[8:11], s28 offen offset:512
s_mov_b32 s30, 0x3f803f80
s_waitcnt vmcnt(0)
v_mov_b32 v56, 0
v_mov_b32 v57, 0
v_dot2_f32_bf16 v56, v16, s30, v56
v_dot2_f32_bf16 v57, v16, v16, v57
v_dot2_f32_bf16 v56, v17, s30, v56
v_dot2_f32_bf16 v57, v17, v17, v57
v_dot2_f32_bf16 v56, v18, s30, v56
v_dot2_f32_bf16 v57, v18, v18, v57
v_dot2_f32_bf16 v56, v19, s30, v56
v_dot2_f32_bf16 v57, v19, v19, v57
v_dot2_f32_bf16 v56, v20, s30, v56
v_dot2_f32_bf16 v57, v20, v20, v57
v_dot2_f32_bf16 v56, v21, s30, v56
v_dot2_f32_bf16 v57, v21, v21, v57
v_dot2_f32_bf16 v56, v22, s30, v56
v_dot2_f32_bf16 v57, v22, v22, v57
v_dot2_f32_bf16 v56, v23, s30, v56
v_dot2_f32_bf16 v57, v23, v23, v57
v_dot2_f32_bf16 v56, v24, s30, v56
v_dot2_f32_bf16 v57, v24, v24, v57
v_dot2_f32_bf16 v56, v25, s30, v56
v_dot2_f32_bf16 v57, v25, v25, v57
v_dot2_f32_bf16 v56, v26, s30, v56
v_dot2_f32_bf16 v57, v26, v26, v57
v_dot2_f32_bf16 v56, v27, s30, v56
v_dot2_f32_bf16 v57, v27, v27, v57
v_dot2_f32_bf16 v56, v28, s30, v56
v_dot2_f32_bf16 v57, v28, v28, v57
v_dot2_f32_bf16 v56, v29, s30, v56
v_dot2_f32_bf16 v57, v29, v29, v57
v_dot2_f32_bf16 v56, v30, s30, v56
v_dot2_f32_bf16 v57, v30, v30, v57
v_dot2_f32_bf16 v56, v31, s30, v56
v_dot2_f32_bf16 v57, v31, v31, v57
v_dot2_f32_bf16 v56, v32, s30, v56
v_dot2_f32_bf16 v57, v32, v32, v57
v_dot2_f32_bf16 v56, v33, s30, v56
v_dot2_f32_bf16 v57, v33, v33, v57
v_dot2_f32_bf16 v56, v34, s30, v56
v_dot2_f32_bf16 v57, v34, v34, v57
v_dot2_f32_bf16 v56, v35, s30, v56
v_dot2_f32_bf16 v57, v35, v35, v57
v_dot2_f32_bf16 v56, v36, s30, v56
v_dot2_f32_bf16 v57, v36, v36, v57
v_dot2_f32_bf16 v56, v37, s30, v56
v_dot2_f32_bf16 v57, v37, v37, v57
v_dot2_f32_bf16 v56, v38, s30, v56
v_dot2_f32_bf16 v57, v38, v38, v57
v_dot2_f32_bf16 v56, v39, s30, v56
v_dot2_f32_bf16 v57, v39, v39, v57
v_dot2_f32_bf16 v56, v40, s30, v56
v_dot2_f32_bf16 v57, v40, v40, v57
v_dot2_f32_bf16 v56, v41, s30, v56
v_dot2_f32_bf16 v57, v41, v41, v57
v_dot2_f32_bf16 v56, v42, s30, v56
v_dot2_f32_bf16 v57, v42, v42, v57
v_dot2_f32_bf16 v56, v43, s30, v56
v_dot2_f32_bf16 v57, v43, v43, v57
v_dot2_f32_bf16 v56, v44, s30, v56
v_dot2_f32_bf16 v57, v44, v44, v57
v_dot2_f32_bf16 v56, v45, s30, v56
v_dot2_f32_bf16 v57, v45, v45, v57
v_dot2_f32_bf16 v56, v46, s30, v56
v_dot2_f32_bf16 v57, v46, v46, v57
v_dot2_f32_bf16 v56, v47, s30, v56
v_dot2_f32_bf16 v57, v47, v47, v57
v_dot2_f32_bf16 v56, v48, s30, v56
v_dot2_f32_bf16 v57, v48, v48, v57
v_dot2_f32_bf16 v56, v49, s30, v56
v_dot2_f32_bf16 v57, v49, v49, v57
v_dot2_f32_bf16 v56, v50, s30, v56
v_dot2_f32_bf16 v57, v50, v50, v57
v_dot2_f32_bf16 v56, v51, s30, v56
v_dot2_f32_bf16 v57, v51, v51, v57
s_nop 1
v_mov_b32 v58, v56
s_nop 1
v_permlane16_swap_b32 v56, v58
v_add_f32 v56, v56, v58
v_mov_b32 v58, v56
s_nop 1
v_permlane32_swap_b32 v56, v58
v_add_f32 v56, v56, v58
v_mov_b32 v58, v57
s_nop 1
v_permlane16_swap_b32 v57, v58
v_add_f32 v57, v57, v58
v_mov_b32 v58, v57
s_nop 1
v_permlane32_swap_b32 v57, v58
v_add_f32 v57, v57, v58
s_lshl_b32 s28, s22, 7
v_lshlrev_b32 v6, 3, v2
v_add_u32 v7, s28, v6
ds_write_b64 v7, v[56:57]
s_waitcnt lgkmcnt(0)
s_barrier
s_xor_b32 s28, s22, 1
s_lshl_b32 s28, s28, 7
v_add_u32 v7, s28, v6
ds_read_b64 v[58:59], v7
s_waitcnt lgkmcnt(0)
v_add_f32 v56, v56, v58
v_add_f32 v57, v57, v59
v_mul_f32 v56, 0x3ae38e39, v56
v_mul_f32 v57, 0x3ae38e39, v57
v_fma_f32 v57, -v56, v56, v57
v_max_f32 v57, 0, v57
v_add_f32 v57, 0x3727c5ac, v57
v_rsq_f32 v60, v57
s_nop 0
v_mul_f32 v62, v56, v60
v_sub_f32 v62, 0, v62
v_mov_b32 v61, v60
v_mov_b32 v63, v62
s_lshr_b32 s28, s23, 1
s_mul_i32 s28, s28, 73728
s_and_b32 s29, s23, 1
s_lshl_b32 s29, s29, 1
s_add_u32 s29, s29, s26
s_lshl_b32 s29, s29, 10
s_add_u32 s28, s28, s29
s_mul_i32 s29, s27, 36864
s_add_u32 s28, s28, s29
v_lshlrev_b32 v64, 16, v16
v_and_b32 v65, 0xffff0000, v16
v_lshlrev_b32 v66, 16, v17
v_and_b32 v67, 0xffff0000, v17
v_lshlrev_b32 v68, 16, v18
v_and_b32 v69, 0xffff0000, v18
v_lshlrev_b32 v70, 16, v19
v_and_b32 v71, 0xffff0000, v19
v_pk_fma_f32 v[64:65], v[64:65], v[60:61], v[62:63]
v_pk_fma_f32 v[66:67], v[66:67], v[60:61], v[62:63]
v_pk_fma_f32 v[68:69], v[68:69], v[60:61], v[62:63]
v_pk_fma_f32 v[70:71], v[70:71], v[60:61], v[62:63]
v_cvt_pk_bf16_f32 v72, v64, v65
v_cvt_pk_bf16_f32 v73, v66, v67
v_cvt_pk_bf16_f32 v74, v68, v69
v_cvt_pk_bf16_f32 v75, v70, v71
buffer_store_dwordx4 v[72:75], v4, s[12:15], s28 offen sc0 sc1
s_add_u32 s28, s28, 4096
v_lshlrev_b32 v64, 16, v20
v_and_b32 v65, 0xffff0000, v20
v_lshlrev_b32 v66, 16, v21
v_and_b32 v67, 0xffff0000, v21
v_lshlrev_b32 v68, 16, v22
v_and_b32 v69, 0xffff0000, v22
v_lshlrev_b32 v70, 16, v23
v_and_b32 v71, 0xffff0000, v23
v_pk_fma_f32 v[64:65], v[64:65], v[60:61], v[62:63]
v_pk_fma_f32 v[66:67], v[66:67], v[60:61], v[62:63]
v_pk_fma_f32 v[68:69], v[68:69], v[60:61], v[62:63]
v_pk_fma_f32 v[70:71], v[70:71], v[60:61], v[62:63]
v_cvt_pk_bf16_f32 v76, v64, v65
v_cvt_pk_bf16_f32 v77, v66, v67
v_cvt_pk_bf16_f32 v78, v68, v69
v_cvt_pk_bf16_f32 v79, v70, v71
buffer_store_dwordx4 v[76:79], v4, s[12:15], s28 offen sc0 sc1
s_add_u32 s28, s28, 4096
v_lshlrev_b32 v64, 16, v24
v_and_b32 v65, 0xffff0000, v24
v_lshlrev_b32 v66, 16, v25
v_and_b32 v67, 0xffff0000, v25
v_lshlrev_b32 v68, 16, v26
v_and_b32 v69, 0xffff0000, v26
v_lshlrev_b32 v70, 16, v27
v_and_b32 v71, 0xffff0000, v27
v_pk_fma_f32 v[64:65], v[64:65], v[60:61], v[62:63]
v_pk_fma_f32 v[66:67], v[66:67], v[60:61], v[62:63]
v_pk_fma_f32 v[68:69], v[68:69], v[60:61], v[62:63]
v_pk_fma_f32 v[70:71], v[70:71], v[60:61], v[62:63]
v_cvt_pk_bf16_f32 v72, v64, v65
v_cvt_pk_bf16_f32 v73, v66, v67
v_cvt_pk_bf16_f32 v74, v68, v69
v_cvt_pk_bf16_f32 v75, v70, v71
buffer_store_dwordx4 v[72:75], v4, s[12:15], s28 offen sc0 sc1
s_add_u32 s28, s28, 4096
v_lshlrev_b32 v64, 16, v28
v_and_b32 v65, 0xffff0000, v28
v_lshlrev_b32 v66, 16, v29
v_and_b32 v67, 0xffff0000, v29
v_lshlrev_b32 v68, 16, v30
v_and_b32 v69, 0xffff0000, v30
v_lshlrev_b32 v70, 16, v31
v_and_b32 v71, 0xffff0000, v31
v_pk_fma_f32 v[64:65], v[64:65], v[60:61], v[62:63]
v_pk_fma_f32 v[66:67], v[66:67], v[60:61], v[62:63]
v_pk_fma_f32 v[68:69], v[68:69], v[60:61], v[62:63]
v_pk_fma_f32 v[70:71], v[70:71], v[60:61], v[62:63]
v_cvt_pk_bf16_f32 v76, v64, v65
v_cvt_pk_bf16_f32 v77, v66, v67
v_cvt_pk_bf16_f32 v78, v68, v69
v_cvt_pk_bf16_f32 v79, v70, v71
buffer_store_dwordx4 v[76:79], v4, s[12:15], s28 offen sc0 sc1
s_add_u32 s28, s28, 4096
v_lshlrev_b32 v64, 16, v32
v_and_b32 v65, 0xffff0000, v32
v_lshlrev_b32 v66, 16, v33
v_and_b32 v67, 0xffff0000, v33
v_lshlrev_b32 v68, 16, v34
v_and_b32 v69, 0xffff0000, v34
v_lshlrev_b32 v70, 16, v35
v_and_b32 v71, 0xffff0000, v35
v_pk_fma_f32 v[64:65], v[64:65], v[60:61], v[62:63]
v_pk_fma_f32 v[66:67], v[66:67], v[60:61], v[62:63]
v_pk_fma_f32 v[68:69], v[68:69], v[60:61], v[62:63]
v_pk_fma_f32 v[70:71], v[70:71], v[60:61], v[62:63]
v_cvt_pk_bf16_f32 v72, v64, v65
v_cvt_pk_bf16_f32 v73, v66, v67
v_cvt_pk_bf16_f32 v74, v68, v69
v_cvt_pk_bf16_f32 v75, v70, v71
buffer_store_dwordx4 v[72:75], v4, s[12:15], s28 offen sc0 sc1
s_add_u32 s28, s28, 4096
v_lshlrev_b32 v64, 16, v36
v_and_b32 v65, 0xffff0000, v36
v_lshlrev_b32 v66, 16, v37
v_and_b32 v67, 0xffff0000, v37
v_lshlrev_b32 v68, 16, v38
v_and_b32 v69, 0xffff0000, v38
v_lshlrev_b32 v70, 16, v39
v_and_b32 v71, 0xffff0000, v39
v_pk_fma_f32 v[64:65], v[64:65], v[60:61], v[62:63]
v_pk_fma_f32 v[66:67], v[66:67], v[60:61], v[62:63]
v_pk_fma_f32 v[68:69], v[68:69], v[60:61], v[62:63]
v_pk_fma_f32 v[70:71], v[70:71], v[60:61], v[62:63]
v_cvt_pk_bf16_f32 v76, v64, v65
v_cvt_pk_bf16_f32 v77, v66, v67
v_cvt_pk_bf16_f32 v78, v68, v69
v_cvt_pk_bf16_f32 v79, v70, v71
buffer_store_dwordx4 v[76:79], v4, s[12:15], s28 offen sc0 sc1
s_add_u32 s28, s28, 4096
v_lshlrev_b32 v64, 16, v40
v_and_b32 v65, 0xffff0000, v40
v_lshlrev_b32 v66, 16, v41
v_and_b32 v67, 0xffff0000, v41
v_lshlrev_b32 v68, 16, v42
v_and_b32 v69, 0xffff0000, v42
v_lshlrev_b32 v70, 16, v43
v_and_b32 v71, 0xffff0000, v43
v_pk_fma_f32 v[64:65], v[64:65], v[60:61], v[62:63]
v_pk_fma_f32 v[66:67], v[66:67], v[60:61], v[62:63]
v_pk_fma_f32 v[68:69], v[68:69], v[60:61], v[62:63]
v_pk_fma_f32 v[70:71], v[70:71], v[60:61], v[62:63]
v_cvt_pk_bf16_f32 v72, v64, v65
v_cvt_pk_bf16_f32 v73, v66, v67
v_cvt_pk_bf16_f32 v74, v68, v69
v_cvt_pk_bf16_f32 v75, v70, v71
buffer_store_dwordx4 v[72:75], v4, s[12:15], s28 offen sc0 sc1
s_add_u32 s28, s28, 4096
v_lshlrev_b32 v64, 16, v44
v_and_b32 v65, 0xffff0000, v44
v_lshlrev_b32 v66, 16, v45
v_and_b32 v67, 0xffff0000, v45
v_lshlrev_b32 v68, 16, v46
v_and_b32 v69, 0xffff0000, v46
v_lshlrev_b32 v70, 16, v47
v_and_b32 v71, 0xffff0000, v47
v_pk_fma_f32 v[64:65], v[64:65], v[60:61], v[62:63]
v_pk_fma_f32 v[66:67], v[66:67], v[60:61], v[62:63]
v_pk_fma_f32 v[68:69], v[68:69], v[60:61], v[62:63]
v_pk_fma_f32 v[70:71], v[70:71], v[60:61], v[62:63]
v_cvt_pk_bf16_f32 v76, v64, v65
v_cvt_pk_bf16_f32 v77, v66, v67
v_cvt_pk_bf16_f32 v78, v68, v69
v_cvt_pk_bf16_f32 v79, v70, v71
buffer_store_dwordx4 v[76:79], v4, s[12:15], s28 offen sc0 sc1
s_add_u32 s28, s28, 4096
v_lshlrev_b32 v64, 16, v48
v_and_b32 v65, 0xffff0000, v48
v_lshlrev_b32 v66, 16, v49
v_and_b32 v67, 0xffff0000, v49
v_lshlrev_b32 v68, 16, v50
v_and_b32 v69, 0xffff0000, v50
v_lshlrev_b32 v70, 16, v51
v_and_b32 v71, 0xffff0000, v51
v_pk_fma_f32 v[64:65], v[64:65], v[60:61], v[62:63]
v_pk_fma_f32 v[66:67], v[66:67], v[60:61], v[62:63]
v_pk_fma_f32 v[68:69], v[68:69], v[60:61], v[62:63]
v_pk_fma_f32 v[70:71], v[70:71], v[60:61], v[62:63]
v_cvt_pk_bf16_f32 v72, v64, v65
v_cvt_pk_bf16_f32 v73, v66, v67
v_cvt_pk_bf16_f32 v74, v68, v69
v_cvt_pk_bf16_f32 v75, v70, v71
buffer_store_dwordx4 v[72:75], v4, s[12:15], s28 offen sc0 sc1
s_mov_b64 exec, -1
s_branch kf_task_done
kf_wqkv:
s_cmp_eq_u32 s46, 0
s_cbranch_scc1 kf_wqkv_go
s_branch kf_task_done
kf_wqkv_go:
s_sub_u32 s23, s2, 100
s_lshl_b32 s23, s23, 2
s_add_u32 s23, s23, s22
s_load_dwordx2 s[4:5], s[0:1], 8
s_load_dwordx2 s[6:7], s[0:1], 16
s_load_dwordx2 s[20:21], s[0:1], 88
v_and_b32 v1, 63, v0
s_mul_i32 s24, s22, 9216
v_add_u32 v2, 0, v1
v_mul_u32_u24 v10, 3641, v2
v_lshrrev_b32 v10, 16, v10
v_mul_u32_u24 v3, 18, v10
v_sub_u32 v20, v2, v3
v_add_u32 v2, 64, v1
v_mul_u32_u24 v11, 3641, v2
v_lshrrev_b32 v11, 16, v11
v_mul_u32_u24 v3, 18, v11
v_sub_u32 v21, v2, v3
v_add_u32 v2, 128, v1
v_mul_u32_u24 v12, 3641, v2
v_lshrrev_b32 v12, 16, v12
v_mul_u32_u24 v3, 18, v12
v_sub_u32 v22, v2, v3
v_add_u32 v2, 192, v1
v_mul_u32_u24 v13, 3641, v2
v_lshrrev_b32 v13, 16, v13
v_mul_u32_u24 v3, 18, v13
v_sub_u32 v23, v2, v3
v_add_u32 v2, 256, v1
v_mul_u32_u24 v14, 3641, v2
v_lshrrev_b32 v14, 16, v14
v_mul_u32_u24 v3, 18, v14
v_sub_u32 v24, v2, v3
v_add_u32 v2, 320, v1
v_mul_u32_u24 v15, 3641, v2
v_lshrrev_b32 v15, 16, v15
v_mul_u32_u24 v3, 18, v15
v_sub_u32 v25, v2, v3
v_add_u32 v2, 384, v1
v_mul_u32_u24 v16, 3641, v2
v_lshrrev_b32 v16, 16, v16
v_mul_u32_u24 v3, 18, v16
v_sub_u32 v26, v2, v3
v_add_u32 v2, 448, v1
v_mul_u32_u24 v17, 3641, v2
v_lshrrev_b32 v17, 16, v17
v_mul_u32_u24 v3, 18, v17
v_sub_u32 v27, v2, v3
v_add_u32 v2, 512, v1
v_mul_u32_u24 v18, 3641, v2
v_lshrrev_b32 v18, 16, v18
v_mul_u32_u24 v3, 18, v18
v_sub_u32 v28, v2, v3
v_and_b32 v4, 15, v1
v_lshrrev_b32 v5, 4, v1
v_lshlrev_b32 v6, 4, v1
v_add_u32 v7, s24, v6
v_mul_u32_u24 v8, 2304, v5
v_add_u32 v8, s24, v8
s_waitcnt lgkmcnt(0)
s_mov_b32 s8, s4
s_mov_b32 s9, s5
s_mov_b32 s10, 0x1e6000
s_mov_b32 s11, 0x00020000
s_add_u32 s12, s20, 0x10000
s_addc_u32 s13, s21, 0
s_mov_b32 s14, 0x1e6000
s_mov_b32 s15, 0x00020000
s_mul_hi_u32 s25, s23, 0x15555556
s_mul_i32 s27, s25, 12
s_sub_u32 s26, s23, s27
s_lshr_b32 s27, s26, 2
s_and_b32 s28, s26, 3
s_mul_i32 s29, s25, 110592
s_mul_i32 s30, s27, 1152
s_add_u32 s29, s29, s30
s_mul_i32 s30, s28, 288
s_add_u32 s29, s29, s30
v_mul_u32_u24 v2, 3456, v10
v_lshl_add_u32 v2, v20, 4, v2
buffer_load_dwordx4 v[32:35], v2, s[8:11], s29 offen
v_mul_u32_u24 v2, 3456, v11
v_lshl_add_u32 v2, v21, 4, v2
buffer_load_dwordx4 v[36:39], v2, s[8:11], s29 offen
v_mul_u32_u24 v2, 3456, v12
v_lshl_add_u32 v2, v22, 4, v2
buffer_load_dwordx4 v[40:43], v2, s[8:11], s29 offen
v_mul_u32_u24 v2, 3456, v13
v_lshl_add_u32 v2, v23, 4, v2
buffer_load_dwordx4 v[44:47], v2, s[8:11], s29 offen
v_mul_u32_u24 v2, 3456, v14
v_lshl_add_u32 v2, v24, 4, v2
buffer_load_dwordx4 v[48:51], v2, s[8:11], s29 offen
v_mul_u32_u24 v2, 3456, v15
v_lshl_add_u32 v2, v25, 4, v2
buffer_load_dwordx4 v[52:55], v2, s[8:11], s29 offen
v_mul_u32_u24 v2, 3456, v16
v_lshl_add_u32 v2, v26, 4, v2
buffer_load_dwordx4 v[56:59], v2, s[8:11], s29 offen
v_mul_u32_u24 v2, 3456, v17
v_lshl_add_u32 v2, v27, 4, v2
buffer_load_dwordx4 v[60:63], v2, s[8:11], s29 offen
v_mul_u32_u24 v2, 3456, v18
v_lshl_add_u32 v2, v28, 4, v2
buffer_load_dwordx4 v[64:67], v2, s[8:11], s29 offen
s_waitcnt vmcnt(8)
ds_write_b128 v7, v[32:35] offset:0
s_waitcnt vmcnt(7)
ds_write_b128 v7, v[36:39] offset:1024
s_waitcnt vmcnt(6)
ds_write_b128 v7, v[40:43] offset:2048
s_waitcnt vmcnt(5)
ds_write_b128 v7, v[44:47] offset:3072
s_waitcnt vmcnt(4)
ds_write_b128 v7, v[48:51] offset:4096
s_waitcnt vmcnt(3)
ds_write_b128 v7, v[52:55] offset:5120
s_waitcnt vmcnt(2)
ds_write_b128 v7, v[56:59] offset:6144
s_waitcnt vmcnt(1)
ds_write_b128 v7, v[60:63] offset:7168
s_waitcnt vmcnt(0)
ds_write_b128 v7, v[64:67] offset:8192
v_lshl_add_u32 v2, v4, 1, v8
v_lshrrev_b32 v3, 1, v4
v_mul_u32_u24 v3, 36, v3
v_and_b32 v9, 1, v4
v_lshl_add_u32 v3, v9, 1, v3
v_add_u32 v3, 32, v3
v_add_u32 v3, v3, v8
s_waitcnt lgkmcnt(0)
ds_read_u16 v72, v2 offset:0
ds_read_u16 v73, v2 offset:288
ds_read_u16 v74, v2 offset:576
ds_read_u16 v75, v2 offset:864
ds_read_u16 v76, v2 offset:1152
ds_read_u16 v77, v2 offset:1440
ds_read_u16 v78, v2 offset:1728
ds_read_u16 v79, v2 offset:2016
s_waitcnt lgkmcnt(0)
v_lshl_or_b32 v32, v73, 16, v72
v_lshl_or_b32 v33, v75, 16, v74
v_lshl_or_b32 v34, v77, 16, v76
v_lshl_or_b32 v35, v79, 16, v78
ds_read_u16 v72, v2 offset:36
ds_read_u16 v73, v2 offset:324
ds_read_u16 v74, v2 offset:612
ds_read_u16 v75, v2 offset:900
ds_read_u16 v76, v2 offset:1188
ds_read_u16 v77, v2 offset:1476
ds_read_u16 v78, v2 offset:1764
ds_read_u16 v79, v2 offset:2052
s_waitcnt lgkmcnt(0)
v_lshl_or_b32 v36, v73, 16, v72
v_lshl_or_b32 v37, v75, 16, v74
v_lshl_or_b32 v38, v77, 16, v76
v_lshl_or_b32 v39, v79, 16, v78
ds_read_u16 v72, v2 offset:72
ds_read_u16 v73, v2 offset:360
ds_read_u16 v74, v2 offset:648
ds_read_u16 v75, v2 offset:936
ds_read_u16 v76, v2 offset:1224
ds_read_u16 v77, v2 offset:1512
ds_read_u16 v78, v2 offset:1800
ds_read_u16 v79, v2 offset:2088
s_waitcnt lgkmcnt(0)
v_lshl_or_b32 v40, v73, 16, v72
v_lshl_or_b32 v41, v75, 16, v74
v_lshl_or_b32 v42, v77, 16, v76
v_lshl_or_b32 v43, v79, 16, v78
ds_read_u16 v72, v2 offset:108
ds_read_u16 v73, v2 offset:396
ds_read_u16 v74, v2 offset:684
ds_read_u16 v75, v2 offset:972
ds_read_u16 v76, v2 offset:1260
ds_read_u16 v77, v2 offset:1548
ds_read_u16 v78, v2 offset:1836
ds_read_u16 v79, v2 offset:2124
s_waitcnt lgkmcnt(0)
v_lshl_or_b32 v44, v73, 16, v72
v_lshl_or_b32 v45, v75, 16, v74
v_lshl_or_b32 v46, v77, 16, v76
v_lshl_or_b32 v47, v79, 16, v78
ds_read_u16 v72, v2 offset:144
ds_read_u16 v73, v2 offset:432
ds_read_u16 v74, v2 offset:720
ds_read_u16 v75, v2 offset:1008
ds_read_u16 v76, v2 offset:1296
ds_read_u16 v77, v2 offset:1584
ds_read_u16 v78, v2 offset:1872
ds_read_u16 v79, v2 offset:2160
s_waitcnt lgkmcnt(0)
v_lshl_or_b32 v48, v73, 16, v72
v_lshl_or_b32 v49, v75, 16, v74
v_lshl_or_b32 v50, v77, 16, v76
v_lshl_or_b32 v51, v79, 16, v78
ds_read_u16 v72, v2 offset:180
ds_read_u16 v73, v2 offset:468
ds_read_u16 v74, v2 offset:756
ds_read_u16 v75, v2 offset:1044
ds_read_u16 v76, v2 offset:1332
ds_read_u16 v77, v2 offset:1620
ds_read_u16 v78, v2 offset:1908
ds_read_u16 v79, v2 offset:2196
s_waitcnt lgkmcnt(0)
v_lshl_or_b32 v52, v73, 16, v72
v_lshl_or_b32 v53, v75, 16, v74
v_lshl_or_b32 v54, v77, 16, v76
v_lshl_or_b32 v55, v79, 16, v78
ds_read_u16 v72, v2 offset:216
ds_read_u16 v73, v2 offset:504
ds_read_u16 v74, v2 offset:792
ds_read_u16 v75, v2 offset:1080
ds_read_u16 v76, v2 offset:1368
ds_read_u16 v77, v2 offset:1656
ds_read_u16 v78, v2 offset:1944
ds_read_u16 v79, v2 offset:2232
s_waitcnt lgkmcnt(0)
v_lshl_or_b32 v56, v73, 16, v72
v_lshl_or_b32 v57, v75, 16, v74
v_lshl_or_b32 v58, v77, 16, v76
v_lshl_or_b32 v59, v79, 16, v78
ds_read_u16 v72, v2 offset:252
ds_read_u16 v73, v2 offset:540
ds_read_u16 v74, v2 offset:828
ds_read_u16 v75, v2 offset:1116
ds_read_u16 v76, v2 offset:1404
ds_read_u16 v77, v2 offset:1692
ds_read_u16 v78, v2 offset:1980
ds_read_u16 v79, v2 offset:2268
s_waitcnt lgkmcnt(0)
v_lshl_or_b32 v60, v73, 16, v72
v_lshl_or_b32 v61, v75, 16, v74
v_lshl_or_b32 v62, v77, 16, v76
v_lshl_or_b32 v63, v79, 16, v78
ds_read_u16 v72, v3 offset:0
ds_read_u16 v73, v3 offset:288
ds_read_u16 v74, v3 offset:576
ds_read_u16 v75, v3 offset:864
ds_read_u16 v76, v3 offset:1152
ds_read_u16 v77, v3 offset:1440
ds_read_u16 v78, v3 offset:1728
ds_read_u16 v79, v3 offset:2016
s_waitcnt lgkmcnt(0)
v_lshl_or_b32 v64, v73, 16, v72
v_lshl_or_b32 v65, v75, 16, v74
v_lshl_or_b32 v66, v77, 16, v76
v_lshl_or_b32 v67, v79, 16, v78
s_lshl_b32 s30, s27, 4
s_lshl_b32 s31, s28, 2
s_add_u32 s30, s30, s31
s_mul_i32 s30, s30, 18
s_add_u32 s30, s30, s25
s_lshl_b32 s30, s30, 11
s_lshl_b32 s31, s27, 1
s_lshr_b32 s33, s28, 1
s_add_u32 s31, s31, s33
s_add_u32 s31, s31, 48
s_mul_i32 s31, s31, 18
s_add_u32 s31, s31, s25
s_lshl_b32 s31, s31, 11
s_and_b32 s33, s28, 1
s_lshl_b32 s33, s33, 10
s_add_u32 s31, s31, s33
s_waitcnt lgkmcnt(0)
s_add_u32 s33, s30, 0
buffer_store_dwordx4 v[32:35], v6, s[12:15], s33 offen sc0 sc1
s_add_u32 s33, s30, 1024
buffer_store_dwordx4 v[36:39], v6, s[12:15], s33 offen sc0 sc1
s_add_u32 s33, s30, 36864
buffer_store_dwordx4 v[40:43], v6, s[12:15], s33 offen sc0 sc1
s_add_u32 s33, s30, 37888
buffer_store_dwordx4 v[44:47], v6, s[12:15], s33 offen sc0 sc1
s_add_u32 s33, s30, 73728
buffer_store_dwordx4 v[48:51], v6, s[12:15], s33 offen sc0 sc1
s_add_u32 s33, s30, 74752
buffer_store_dwordx4 v[52:55], v6, s[12:15], s33 offen sc0 sc1
s_add_u32 s33, s30, 110592
buffer_store_dwordx4 v[56:59], v6, s[12:15], s33 offen sc0 sc1
s_add_u32 s33, s30, 111616
buffer_store_dwordx4 v[60:63], v6, s[12:15], s33 offen sc0 sc1
buffer_store_dwordx4 v[64:67], v6, s[12:15], s31 offen sc0 sc1
s_mov_b64 exec, -1
s_branch kf_task_done
kf_side:
s_sub_u32 s47, s2, 193
s_and_b32 s47, s47, -2
s_add_u32 s47, s47, s46
s_cmp_ge_u32 s47, 32
s_cbranch_scc1 kf_side1
s_mov_b32 s23, s47
s_load_dwordx2 s[20:21], s[0:1], 88
s_cmp_eq_u32 s23, 0
s_cselect_b32 s25, 1, 0
s_mul_i32 s23, s23, 159744
s_add_u32 s23, s23, 82208
v_and_b32 v2, 255, v0
v_mul_u32_u24 v1, 304, v2
v_mov_b32 v4, 0x3f803f80
v_mov_b32 v5, 0x3f803f80
v_mov_b32 v6, 0x3f803f80
v_mov_b32 v7, 0x3f803f80
s_waitcnt lgkmcnt(0)
s_add_u32 s8, s20, 0x1700000
s_addc_u32 s9, s21, 0
s_mov_b32 s10, 0x4e0000
s_mov_b32 s11, 0x00020000
buffer_store_dwordx4 v[4:7], v1, s[8:11], s23 offen
s_cmp_eq_u32 s25, 0
s_cbranch_scc1 k1_ones_end
s_add_u32 s12, s20, 0x3b00000
s_addc_u32 s13, s21, 0
s_mov_b32 s14, 0x20000
s_mov_b32 s15, 0x00020000
v_lshlrev_b32 v1, 9, v2
v_mov_b32 v8, 0
buffer_store_dword v8, v1, s[12:15], 0 offen sc0 sc1
k1_ones_end:
s_mov_b64 exec, -1
s_branch kf_side1
kf_side1:
s_cmp_ge_u32 s47, 36
s_cbranch_scc1 kf_side2
s_mov_b32 s23, s47
s_load_dwordx2 s[20:21], s[0:1], 88
v_and_b32 v1, 255, v0
v_lshlrev_b32 v1, 4, v1
v_mov_b32 v4, -1
v_mov_b32 v5, -1
v_mov_b32 v6, -1
v_mov_b32 v7, -1
s_waitcnt lgkmcnt(0)
s_add_u32 s8, s20, 0x1c00000
s_addc_u32 s9, s21, 0
s_mov_b32 s10, 0x240000
s_mov_b32 s11, 0x00020000
s_lshl_b32 s24, s23, 16
buffer_store_dwordx4 v[4:7], v1, s[8:11], s24 offen sc0 sc1
s_add_u32 s24, s24, 4096
buffer_store_dwordx4 v[4:7], v1, s[8:11], s24 offen sc0 sc1
s_add_u32 s24, s24, 4096
buffer_store_dwordx4 v[4:7], v1, s[8:11], s24 offen sc0 sc1
s_add_u32 s24, s24, 4096
buffer_store_dwordx4 v[4:7], v1, s[8:11], s24 offen sc0 sc1
s_add_u32 s24, s24, 4096
buffer_store_dwordx4 v[4:7], v1, s[8:11], s24 offen sc0 sc1
s_add_u32 s24, s24, 4096
buffer_store_dwordx4 v[4:7], v1, s[8:11], s24 offen sc0 sc1
s_add_u32 s24, s24, 4096
buffer_store_dwordx4 v[4:7], v1, s[8:11], s24 offen sc0 sc1
s_add_u32 s24, s24, 4096
buffer_store_dwordx4 v[4:7], v1, s[8:11], s24 offen sc0 sc1
s_add_u32 s24, s24, 4096
buffer_store_dwordx4 v[4:7], v1, s[8:11], s24 offen sc0 sc1
s_add_u32 s24, s24, 4096
buffer_store_dwordx4 v[4:7], v1, s[8:11], s24 offen sc0 sc1
s_add_u32 s24, s24, 4096
buffer_store_dwordx4 v[4:7], v1, s[8:11], s24 offen sc0 sc1
s_add_u32 s24, s24, 4096
buffer_store_dwordx4 v[4:7], v1, s[8:11], s24 offen sc0 sc1
s_add_u32 s24, s24, 4096
buffer_store_dwordx4 v[4:7], v1, s[8:11], s24 offen sc0 sc1
s_add_u32 s24, s24, 4096
buffer_store_dwordx4 v[4:7], v1, s[8:11], s24 offen sc0 sc1
s_add_u32 s24, s24, 4096
buffer_store_dwordx4 v[4:7], v1, s[8:11], s24 offen sc0 sc1
s_add_u32 s24, s24, 4096
buffer_store_dwordx4 v[4:7], v1, s[8:11], s24 offen sc0 sc1
s_mov_b64 exec, -1
s_branch kf_side2
kf_side2:
s_cmp_ge_u32 s47, 36
s_cbranch_scc1 kf_side_wo
s_add_u32 s44, s47, 18
s_mul_i32 s45, s46, 12288
s_load_dwordx2 s[4:5], s[0:1], 64
s_load_dwordx2 s[6:7], s[0:1], 56
s_load_dwordx2 s[20:21], s[0:1], 88
v_and_b32 v30, 255, v0
v_and_b32 v1, 7, v30
v_lshrrev_b32 v2, 3, v30
s_waitcnt lgkmcnt(0)
s_mov_b32 s8, s4
s_mov_b32 s9, s5
s_mov_b32 s10, 0x3cc000
s_mov_b32 s11, 0x00020000
s_mov_b32 s12, s6
s_mov_b32 s13, s7
s_mov_b32 s14, 0x480
s_mov_b32 s15, 0x00020000
s_mov_b32 s16, s20
s_mov_b32 s17, s21
s_mov_b32 s18, 0x3600
s_mov_b32 s19, 0x00020000
v_lshlrev_b32 v3, 1, v30
buffer_load_ushort v4, v3, s[12:15], 0 offen
buffer_load_ushort v5, v3, s[12:15], 0 offen offset:512
buffer_load_ushort v6, v3, s[12:15], 0 offen offset:1024
v_mul_u32_u24 v7, 6912, v2
v_lshl_add_u32 v7, v1, 4, v7
s_mul_i32 s22, s44, 128
buffer_load_dwordx4 v[32:35], v7, s[8:11], s22 offen
s_add_u32 s22, s22, 221184
buffer_load_dwordx4 v[36:39], v7, s[8:11], s22 offen
s_add_u32 s22, s22, 221184
buffer_load_dwordx4 v[40:43], v7, s[8:11], s22 offen
s_add_u32 s22, s22, 221184
buffer_load_dwordx4 v[44:47], v7, s[8:11], s22 offen
s_add_u32 s22, s22, 221184
buffer_load_dwordx4 v[48:51], v7, s[8:11], s22 offen
s_add_u32 s22, s22, 221184
buffer_load_dwordx4 v[52:55], v7, s[8:11], s22 offen
s_add_u32 s22, s22, 221184
buffer_load_dwordx4 v[56:59], v7, s[8:11], s22 offen
s_add_u32 s22, s22, 221184
buffer_load_dwordx4 v[60:63], v7, s[8:11], s22 offen
s_add_u32 s22, s22, 221184
buffer_load_dwordx4 v[64:67], v7, s[8:11], s22 offen
s_add_u32 s22, s22, 221184
buffer_load_dwordx4 v[68:71], v7, s[8:11], s22 offen
s_add_u32 s22, s22, 221184
buffer_load_dwordx4 v[72:75], v7, s[8:11], s22 offen
s_add_u32 s22, s22, 221184
buffer_load_dwordx4 v[76:79], v7, s[8:11], s22 offen
s_add_u32 s22, s22, 221184
buffer_load_dwordx4 v[80:83], v7, s[8:11], s22 offen
s_add_u32 s22, s22, 221184
buffer_load_dwordx4 v[84:87], v7, s[8:11], s22 offen
s_add_u32 s22, s22, 221184
buffer_load_dwordx4 v[88:91], v7, s[8:11], s22 offen
s_add_u32 s22, s22, 221184
buffer_load_dwordx4 v[92:95], v7, s[8:11], s22 offen
s_add_u32 s22, s22, 221184
buffer_load_dwordx4 v[96:99], v7, s[8:11], s22 offen
s_add_u32 s22, s22, 221184
buffer_load_dwordx4 v[100:103], v7, s[8:11], s22 offen
v_lshlrev_b32 v9, 2, v30
v_add_u32 v9, s45, v9
s_waitcnt vmcnt(18)
v_lshlrev_b32 v4, 16, v4
v_mul_f32 v8, 0x3fb8aa3b, v4
v_exp_f32 v8, -v8
s_nop 0
v_add_f32 v8, 1.0, v8
v_rcp_f32 v8, v8
s_nop 0
v_mul_f32 v8, v8, v4
v_cvt_pk_bf16_f32 v8, v8, v8
v_and_b32 v8, 0xffff0000, v8
ds_write_b32 v9, v8 offset:0
v_lshlrev_b32 v5, 16, v5
v_mul_f32 v8, 0x3fb8aa3b, v5
v_exp_f32 v8, -v8
s_nop 0
v_add_f32 v8, 1.0, v8
v_rcp_f32 v8, v8
s_nop 0
v_mul_f32 v8, v8, v5
v_cvt_pk_bf16_f32 v8, v8, v8
v_and_b32 v8, 0xffff0000, v8
ds_write_b32 v9, v8 offset:1024
v_lshlrev_b32 v6, 16, v6
v_mul_f32 v8, 0x3fb8aa3b, v6
v_exp_f32 v8, -v8
s_nop 0
v_add_f32 v8, 1.0, v8
v_rcp_f32 v8, v8
s_nop 0
v_mul_f32 v8, v8, v6
v_cvt_pk_bf16_f32 v8, v8, v8
v_and_b32 v8, 0xffff0000, v8
ds_write_b32 v9, v8 offset:2048
s_waitcnt lgkmcnt(0)
s_barrier
v_lshlrev_b32 v9, 2, v2
v_add_u32 v9, s45, v9
ds_read_b32 v10, v9 offset:0
ds_read_b32 v11, v9 offset:128
ds_read_b32 v12, v9 offset:256
ds_read_b32 v13, v9 offset:384
ds_read_b32 v14, v9 offset:512
ds_read_b32 v15, v9 offset:640
ds_read_b32 v16, v9 offset:768
ds_read_b32 v17, v9 offset:896
ds_read_b32 v18, v9 offset:1024
ds_read_b32 v19, v9 offset:1152
ds_read_b32 v20, v9 offset:1280
ds_read_b32 v21, v9 offset:1408
ds_read_b32 v22, v9 offset:1536
ds_read_b32 v23, v9 offset:1664
ds_read_b32 v24, v9 offset:1792
ds_read_b32 v25, v9 offset:1920
ds_read_b32 v26, v9 offset:2048
ds_read_b32 v27, v9 offset:2176
v_mov_b32 v104, 0
v_mov_b32 v105, 0
v_mov_b32 v106, 0
v_mov_b32 v107, 0
v_mov_b32 v108, 0
v_mov_b32 v109, 0
v_mov_b32 v110, 0
v_mov_b32 v111, 0
s_waitcnt lgkmcnt(0)
s_waitcnt vmcnt(17)
v_lshrrev_b32 v28, 16, v10
v_dot2_f32_bf16 v104, v32, v28, v104
v_dot2_f32_bf16 v105, v32, v10, v105
v_dot2_f32_bf16 v106, v33, v28, v106
v_dot2_f32_bf16 v107, v33, v10, v107
v_dot2_f32_bf16 v108, v34, v28, v108
v_dot2_f32_bf16 v109, v34, v10, v109
v_dot2_f32_bf16 v110, v35, v28, v110
v_dot2_f32_bf16 v111, v35, v10, v111
s_waitcnt vmcnt(16)
v_lshrrev_b32 v28, 16, v11
v_dot2_f32_bf16 v104, v36, v28, v104
v_dot2_f32_bf16 v105, v36, v11, v105
v_dot2_f32_bf16 v106, v37, v28, v106
v_dot2_f32_bf16 v107, v37, v11, v107
v_dot2_f32_bf16 v108, v38, v28, v108
v_dot2_f32_bf16 v109, v38, v11, v109
v_dot2_f32_bf16 v110, v39, v28, v110
v_dot2_f32_bf16 v111, v39, v11, v111
s_waitcnt vmcnt(15)
v_lshrrev_b32 v28, 16, v12
v_dot2_f32_bf16 v104, v40, v28, v104
v_dot2_f32_bf16 v105, v40, v12, v105
v_dot2_f32_bf16 v106, v41, v28, v106
v_dot2_f32_bf16 v107, v41, v12, v107
v_dot2_f32_bf16 v108, v42, v28, v108
v_dot2_f32_bf16 v109, v42, v12, v109
v_dot2_f32_bf16 v110, v43, v28, v110
v_dot2_f32_bf16 v111, v43, v12, v111
s_waitcnt vmcnt(14)
v_lshrrev_b32 v28, 16, v13
v_dot2_f32_bf16 v104, v44, v28, v104
v_dot2_f32_bf16 v105, v44, v13, v105
v_dot2_f32_bf16 v106, v45, v28, v106
v_dot2_f32_bf16 v107, v45, v13, v107
v_dot2_f32_bf16 v108, v46, v28, v108
v_dot2_f32_bf16 v109, v46, v13, v109
v_dot2_f32_bf16 v110, v47, v28, v110
v_dot2_f32_bf16 v111, v47, v13, v111
s_waitcnt vmcnt(13)
v_lshrrev_b32 v28, 16, v14
v_dot2_f32_bf16 v104, v48, v28, v104
v_dot2_f32_bf16 v105, v48, v14, v105
v_dot2_f32_bf16 v106, v49, v28, v106
v_dot2_f32_bf16 v107, v49, v14, v107
v_dot2_f32_bf16 v108, v50, v28, v108
v_dot2_f32_bf16 v109, v50, v14, v109
v_dot2_f32_bf16 v110, v51, v28, v110
v_dot2_f32_bf16 v111, v51, v14, v111
s_waitcnt vmcnt(12)
v_lshrrev_b32 v28, 16, v15
v_dot2_f32_bf16 v104, v52, v28, v104
v_dot2_f32_bf16 v105, v52, v15, v105
v_dot2_f32_bf16 v106, v53, v28, v106
v_dot2_f32_bf16 v107, v53, v15, v107
v_dot2_f32_bf16 v108, v54, v28, v108
v_dot2_f32_bf16 v109, v54, v15, v109
v_dot2_f32_bf16 v110, v55, v28, v110
v_dot2_f32_bf16 v111, v55, v15, v111
s_waitcnt vmcnt(11)
v_lshrrev_b32 v28, 16, v16
v_dot2_f32_bf16 v104, v56, v28, v104
v_dot2_f32_bf16 v105, v56, v16, v105
v_dot2_f32_bf16 v106, v57, v28, v106
v_dot2_f32_bf16 v107, v57, v16, v107
v_dot2_f32_bf16 v108, v58, v28, v108
v_dot2_f32_bf16 v109, v58, v16, v109
v_dot2_f32_bf16 v110, v59, v28, v110
v_dot2_f32_bf16 v111, v59, v16, v111
s_waitcnt vmcnt(10)
v_lshrrev_b32 v28, 16, v17
v_dot2_f32_bf16 v104, v60, v28, v104
v_dot2_f32_bf16 v105, v60, v17, v105
v_dot2_f32_bf16 v106, v61, v28, v106
v_dot2_f32_bf16 v107, v61, v17, v107
v_dot2_f32_bf16 v108, v62, v28, v108
v_dot2_f32_bf16 v109, v62, v17, v109
v_dot2_f32_bf16 v110, v63, v28, v110
v_dot2_f32_bf16 v111, v63, v17, v111
s_waitcnt vmcnt(9)
v_lshrrev_b32 v28, 16, v18
v_dot2_f32_bf16 v104, v64, v28, v104
v_dot2_f32_bf16 v105, v64, v18, v105
v_dot2_f32_bf16 v106, v65, v28, v106
v_dot2_f32_bf16 v107, v65, v18, v107
v_dot2_f32_bf16 v108, v66, v28, v108
v_dot2_f32_bf16 v109, v66, v18, v109
v_dot2_f32_bf16 v110, v67, v28, v110
v_dot2_f32_bf16 v111, v67, v18, v111
s_waitcnt vmcnt(8)
v_lshrrev_b32 v28, 16, v19
v_dot2_f32_bf16 v104, v68, v28, v104
v_dot2_f32_bf16 v105, v68, v19, v105
v_dot2_f32_bf16 v106, v69, v28, v106
v_dot2_f32_bf16 v107, v69, v19, v107
v_dot2_f32_bf16 v108, v70, v28, v108
v_dot2_f32_bf16 v109, v70, v19, v109
v_dot2_f32_bf16 v110, v71, v28, v110
v_dot2_f32_bf16 v111, v71, v19, v111
s_waitcnt vmcnt(7)
v_lshrrev_b32 v28, 16, v20
v_dot2_f32_bf16 v104, v72, v28, v104
v_dot2_f32_bf16 v105, v72, v20, v105
v_dot2_f32_bf16 v106, v73, v28, v106
v_dot2_f32_bf16 v107, v73, v20, v107
v_dot2_f32_bf16 v108, v74, v28, v108
v_dot2_f32_bf16 v109, v74, v20, v109
v_dot2_f32_bf16 v110, v75, v28, v110
v_dot2_f32_bf16 v111, v75, v20, v111
s_waitcnt vmcnt(6)
v_lshrrev_b32 v28, 16, v21
v_dot2_f32_bf16 v104, v76, v28, v104
v_dot2_f32_bf16 v105, v76, v21, v105
v_dot2_f32_bf16 v106, v77, v28, v106
v_dot2_f32_bf16 v107, v77, v21, v107
v_dot2_f32_bf16 v108, v78, v28, v108
v_dot2_f32_bf16 v109, v78, v21, v109
v_dot2_f32_bf16 v110, v79, v28, v110
v_dot2_f32_bf16 v111, v79, v21, v111
s_waitcnt vmcnt(5)
v_lshrrev_b32 v28, 16, v22
v_dot2_f32_bf16 v104, v80, v28, v104
v_dot2_f32_bf16 v105, v80, v22, v105
v_dot2_f32_bf16 v106, v81, v28, v106
v_dot2_f32_bf16 v107, v81, v22, v107
v_dot2_f32_bf16 v108, v82, v28, v108
v_dot2_f32_bf16 v109, v82, v22, v109
v_dot2_f32_bf16 v110, v83, v28, v110
v_dot2_f32_bf16 v111, v83, v22, v111
s_waitcnt vmcnt(4)
v_lshrrev_b32 v28, 16, v23
v_dot2_f32_bf16 v104, v84, v28, v104
v_dot2_f32_bf16 v105, v84, v23, v105
v_dot2_f32_bf16 v106, v85, v28, v106
v_dot2_f32_bf16 v107, v85, v23, v107
v_dot2_f32_bf16 v108, v86, v28, v108
v_dot2_f32_bf16 v109, v86, v23, v109
v_dot2_f32_bf16 v110, v87, v28, v110
v_dot2_f32_bf16 v111, v87, v23, v111
s_waitcnt vmcnt(3)
v_lshrrev_b32 v28, 16, v24
v_dot2_f32_bf16 v104, v88, v28, v104
v_dot2_f32_bf16 v105, v88, v24, v105
v_dot2_f32_bf16 v106, v89, v28, v106
v_dot2_f32_bf16 v107, v89, v24, v107
v_dot2_f32_bf16 v108, v90, v28, v108
v_dot2_f32_bf16 v109, v90, v24, v109
v_dot2_f32_bf16 v110, v91, v28, v110
v_dot2_f32_bf16 v111, v91, v24, v111
s_waitcnt vmcnt(2)
v_lshrrev_b32 v28, 16, v25
v_dot2_f32_bf16 v104, v92, v28, v104
v_dot2_f32_bf16 v105, v92, v25, v105
v_dot2_f32_bf16 v106, v93, v28, v106
v_dot2_f32_bf16 v107, v93, v25, v107
v_dot2_f32_bf16 v108, v94, v28, v108
v_dot2_f32_bf16 v109, v94, v25, v109
v_dot2_f32_bf16 v110, v95, v28, v110
v_dot2_f32_bf16 v111, v95, v25, v111
s_waitcnt vmcnt(1)
v_lshrrev_b32 v28, 16, v26
v_dot2_f32_bf16 v104, v96, v28, v104
v_dot2_f32_bf16 v105, v96, v26, v105
v_dot2_f32_bf16 v106, v97, v28, v106
v_dot2_f32_bf16 v107, v97, v26, v107
v_dot2_f32_bf16 v108, v98, v28, v108
v_dot2_f32_bf16 v109, v98, v26, v109
v_dot2_f32_bf16 v110, v99, v28, v110
v_dot2_f32_bf16 v111, v99, v26, v111
s_waitcnt vmcnt(0)
v_lshrrev_b32 v28, 16, v27
v_dot2_f32_bf16 v104, v100, v28, v104
v_dot2_f32_bf16 v105, v100, v27, v105
v_dot2_f32_bf16 v106, v101, v28, v106
v_dot2_f32_bf16 v107, v101, v27, v107
v_dot2_f32_bf16 v108, v102, v28, v108
v_dot2_f32_bf16 v109, v102, v27, v109
v_dot2_f32_bf16 v110, v103, v28, v110
v_dot2_f32_bf16 v111, v103, v27, v111
v_mul_u32_u24 v9, 256, v2
v_lshl_add_u32 v9, v1, 5, v9
v_add_u32 v9, s45, v9
ds_write_b128 v9, v[104:107] offset:4096
ds_write_b128 v9, v[108:111] offset:4112
s_waitcnt lgkmcnt(0)
s_barrier
v_cmp_gt_u32 vcc, 64, v30
s_nop 0
s_and_saveexec_b64 s[24:25], vcc
s_cbranch_execz kfb_mod_end
v_and_b32 v10, 63, v30
v_lshlrev_b32 v9, 2, v10
v_add_u32 v3, s45, v9
ds_read_b32 v32, v3 offset:4096
ds_read_b32 v33, v3 offset:4352
ds_read_b32 v34, v3 offset:4608
ds_read_b32 v35, v3 offset:4864
ds_read_b32 v36, v3 offset:5120
ds_read_b32 v37, v3 offset:5376
ds_read_b32 v38, v3 offset:5632
ds_read_b32 v39, v3 offset:5888
ds_read_b32 v40, v3 offset:6144
ds_read_b32 v41, v3 offset:6400
ds_read_b32 v42, v3 offset:6656
ds_read_b32 v43, v3 offset:6912
ds_read_b32 v44, v3 offset:7168
ds_read_b32 v45, v3 offset:7424
ds_read_b32 v46, v3 offset:7680
ds_read_b32 v47, v3 offset:7936
ds_read_b32 v48, v3 offset:8192
ds_read_b32 v49, v3 offset:8448
ds_read_b32 v50, v3 offset:8704
ds_read_b32 v51, v3 offset:8960
ds_read_b32 v52, v3 offset:9216
ds_read_b32 v53, v3 offset:9472
ds_read_b32 v54, v3 offset:9728
ds_read_b32 v55, v3 offset:9984
ds_read_b32 v56, v3 offset:10240
ds_read_b32 v57, v3 offset:10496
ds_read_b32 v58, v3 offset:10752
ds_read_b32 v59, v3 offset:11008
ds_read_b32 v60, v3 offset:11264
ds_read_b32 v61, v3 offset:11520
ds_read_b32 v62, v3 offset:11776
ds_read_b32 v63, v3 offset:12032
s_waitcnt lgkmcnt(0)
v_add_f32 v32, v32, v48
v_add_f32 v33, v33, v49
v_add_f32 v34, v34, v50
v_add_f32 v35, v35, v51
v_add_f32 v36, v36, v52
v_add_f32 v37, v37, v53
v_add_f32 v38, v38, v54
v_add_f32 v39, v39, v55
v_add_f32 v40, v40, v56
v_add_f32 v41, v41, v57
v_add_f32 v42, v42, v58
v_add_f32 v43, v43, v59
v_add_f32 v44, v44, v60
v_add_f32 v45, v45, v61
v_add_f32 v46, v46, v62
v_add_f32 v47, v47, v63
v_add_f32 v32, v32, v40
v_add_f32 v33, v33, v41
v_add_f32 v34, v34, v42
v_add_f32 v35, v35, v43
v_add_f32 v36, v36, v44
v_add_f32 v37, v37, v45
v_add_f32 v38, v38, v46
v_add_f32 v39, v39, v47
v_add_f32 v32, v32, v36
v_add_f32 v33, v33, v37
v_add_f32 v34, v34, v38
v_add_f32 v35, v35, v39
v_add_f32 v32, v32, v34
v_add_f32 v33, v33, v35
v_add_f32 v32, v32, v33
v_cvt_pk_bf16_f32 v32, v32, v32
v_and_b32 v32, 0xffff0000, v32
s_mul_hi_u32 s22, s44, 0x1c71c71d
s_cmp_eq_u32 s22, 1
s_cselect_b32 s23, 1, 0
s_cmp_eq_u32 s22, 4
s_cselect_b32 s23, 1, s23
s_cmp_eq_u32 s23, 0
s_cbranch_scc1 kfb_noone
v_add_f32 v32, 1.0, v32
v_cvt_pk_bf16_f32 v32, v32, v32
v_and_b32 v32, 0xffff0000, v32
kfb_noone:
s_mul_i32 s22, s44, 256
buffer_store_dword v32, v9, s[16:19], s22 offen sc0 sc1
kfb_mod_end:
s_mov_b64 exec, -1
s_branch k2_exit
kf_side_wo:
s_sub_u32 s23, s47, 36
s_lshl_b32 s23, s23, 2
s_and_b32 s24, s22, 3
s_add_u32 s23, s23, s24
s_cmp_ge_u32 s23, 72
s_cbranch_scc1 k2_exit
s_load_dwordx2 s[4:5], s[0:1], 8
s_load_dwordx2 s[6:7], s[0:1], 16
s_load_dwordx2 s[20:21], s[0:1], 88
v_and_b32 v1, 63, v0
s_mul_i32 s24, s22, 9216
v_add_u32 v2, 0, v1
v_mul_u32_u24 v10, 3641, v2
v_lshrrev_b32 v10, 16, v10
v_mul_u32_u24 v3, 18, v10
v_sub_u32 v20, v2, v3
v_add_u32 v2, 64, v1
v_mul_u32_u24 v11, 3641, v2
v_lshrrev_b32 v11, 16, v11
v_mul_u32_u24 v3, 18, v11
v_sub_u32 v21, v2, v3
v_add_u32 v2, 128, v1
v_mul_u32_u24 v12, 3641, v2
v_lshrrev_b32 v12, 16, v12
v_mul_u32_u24 v3, 18, v12
v_sub_u32 v22, v2, v3
v_add_u32 v2, 192, v1
v_mul_u32_u24 v13, 3641, v2
v_lshrrev_b32 v13, 16, v13
v_mul_u32_u24 v3, 18, v13
v_sub_u32 v23, v2, v3
v_add_u32 v2, 256, v1
v_mul_u32_u24 v14, 3641, v2
v_lshrrev_b32 v14, 16, v14
v_mul_u32_u24 v3, 18, v14
v_sub_u32 v24, v2, v3
v_add_u32 v2, 320, v1
v_mul_u32_u24 v15, 3641, v2
v_lshrrev_b32 v15, 16, v15
v_mul_u32_u24 v3, 18, v15
v_sub_u32 v25, v2, v3
v_add_u32 v2, 384, v1
v_mul_u32_u24 v16, 3641, v2
v_lshrrev_b32 v16, 16, v16
v_mul_u32_u24 v3, 18, v16
v_sub_u32 v26, v2, v3
v_add_u32 v2, 448, v1
v_mul_u32_u24 v17, 3641, v2
v_lshrrev_b32 v17, 16, v17
v_mul_u32_u24 v3, 18, v17
v_sub_u32 v27, v2, v3
v_add_u32 v2, 512, v1
v_mul_u32_u24 v18, 3641, v2
v_lshrrev_b32 v18, 16, v18
v_mul_u32_u24 v3, 18, v18
v_sub_u32 v28, v2, v3
v_and_b32 v4, 15, v1
v_lshrrev_b32 v5, 4, v1
v_lshlrev_b32 v6, 4, v1
v_add_u32 v7, s24, v6
v_mul_u32_u24 v8, 2304, v5
v_add_u32 v8, s24, v8
s_waitcnt lgkmcnt(0)
s_mov_b32 s8, s6
s_mov_b32 s9, s7
s_mov_b32 s10, 0xa2000
s_mov_b32 s11, 0x00020000
s_add_u32 s12, s20, 0x200000
s_addc_u32 s13, s21, 0
s_mov_b32 s14, 0xa2000
s_mov_b32 s15, 0x00020000
s_lshr_b32 s25, s23, 2
s_and_b32 s28, s23, 3
s_mul_i32 s29, s28, 288
s_cmp_ge_u32 s25, 16
s_cbranch_scc1 kfo_wo_ext
v_lshrrev_b32 v2, 4, v10
v_mul_u32_u24 v2, 18, v2
v_and_b32 v3, 15, v10
v_add_u32 v10, v2, v3
v_lshrrev_b32 v2, 4, v11
v_mul_u32_u24 v2, 18, v2
v_and_b32 v3, 15, v11
v_add_u32 v11, v2, v3
v_lshrrev_b32 v2, 4, v12
v_mul_u32_u24 v2, 18, v2
v_and_b32 v3, 15, v12
v_add_u32 v12, v2, v3
v_lshrrev_b32 v2, 4, v13
v_mul_u32_u24 v2, 18, v2
v_and_b32 v3, 15, v13
v_add_u32 v13, v2, v3
v_lshrrev_b32 v2, 4, v14
v_mul_u32_u24 v2, 18, v2
v_and_b32 v3, 15, v14
v_add_u32 v14, v2, v3
v_lshrrev_b32 v2, 4, v15
v_mul_u32_u24 v2, 18, v2
v_and_b32 v3, 15, v15
v_add_u32 v15, v2, v3
v_lshrrev_b32 v2, 4, v16
v_mul_u32_u24 v2, 18, v2
v_and_b32 v3, 15, v16
v_add_u32 v16, v2, v3
v_lshrrev_b32 v2, 4, v17
v_mul_u32_u24 v2, 18, v2
v_and_b32 v3, 15, v17
v_add_u32 v17, v2, v3
v_lshrrev_b32 v2, 4, v18
v_mul_u32_u24 v2, 18, v2
v_and_b32 v3, 15, v18
v_add_u32 v18, v2, v3
s_mul_i32 s30, s25, 36
s_branch kfo_wo_j
kfo_wo_ext:
v_lshrrev_b32 v2, 1, v10
v_mul_u32_u24 v2, 18, v2
v_and_b32 v3, 1, v10
v_add_u32 v10, v2, v3
v_lshrrev_b32 v2, 1, v11
v_mul_u32_u24 v2, 18, v2
v_and_b32 v3, 1, v11
v_add_u32 v11, v2, v3
v_lshrrev_b32 v2, 1, v12
v_mul_u32_u24 v2, 18, v2
v_and_b32 v3, 1, v12
v_add_u32 v12, v2, v3
v_lshrrev_b32 v2, 1, v13
v_mul_u32_u24 v2, 18, v2
v_and_b32 v3, 1, v13
v_add_u32 v13, v2, v3
v_lshrrev_b32 v2, 1, v14
v_mul_u32_u24 v2, 18, v2
v_and_b32 v3, 1, v14
v_add_u32 v14, v2, v3
v_lshrrev_b32 v2, 1, v15
v_mul_u32_u24 v2, 18, v2
v_and_b32 v3, 1, v15
v_add_u32 v15, v2, v3
v_lshrrev_b32 v2, 1, v16
v_mul_u32_u24 v2, 18, v2
v_and_b32 v3, 1, v16
v_add_u32 v16, v2, v3
v_lshrrev_b32 v2, 1, v17
v_mul_u32_u24 v2, 18, v2
v_and_b32 v3, 1, v17
v_add_u32 v17, v2, v3
v_lshrrev_b32 v2, 1, v18
v_mul_u32_u24 v2, 18, v2
v_and_b32 v3, 1, v18
v_add_u32 v18, v2, v3
s_sub_u32 s30, s25, 16
s_mul_i32 s30, s30, 288
s_add_u32 s30, s30, 16
kfo_wo_j:
s_mul_i32 s30, s30, 1152
s_add_u32 s29, s29, s30
v_mul_u32_u24 v2, 1152, v10
v_lshl_add_u32 v2, v20, 4, v2
buffer_load_dwordx4 v[32:35], v2, s[8:11], s29 offen
v_mul_u32_u24 v2, 1152, v11
v_lshl_add_u32 v2, v21, 4, v2
buffer_load_dwordx4 v[36:39], v2, s[8:11], s29 offen
v_mul_u32_u24 v2, 1152, v12
v_lshl_add_u32 v2, v22, 4, v2
buffer_load_dwordx4 v[40:43], v2, s[8:11], s29 offen
v_mul_u32_u24 v2, 1152, v13
v_lshl_add_u32 v2, v23, 4, v2
buffer_load_dwordx4 v[44:47], v2, s[8:11], s29 offen
v_mul_u32_u24 v2, 1152, v14
v_lshl_add_u32 v2, v24, 4, v2
buffer_load_dwordx4 v[48:51], v2, s[8:11], s29 offen
v_mul_u32_u24 v2, 1152, v15
v_lshl_add_u32 v2, v25, 4, v2
buffer_load_dwordx4 v[52:55], v2, s[8:11], s29 offen
v_mul_u32_u24 v2, 1152, v16
v_lshl_add_u32 v2, v26, 4, v2
buffer_load_dwordx4 v[56:59], v2, s[8:11], s29 offen
v_mul_u32_u24 v2, 1152, v17
v_lshl_add_u32 v2, v27, 4, v2
buffer_load_dwordx4 v[60:63], v2, s[8:11], s29 offen
v_mul_u32_u24 v2, 1152, v18
v_lshl_add_u32 v2, v28, 4, v2
buffer_load_dwordx4 v[64:67], v2, s[8:11], s29 offen
s_waitcnt vmcnt(8)
ds_write_b128 v7, v[32:35] offset:0
s_waitcnt vmcnt(7)
ds_write_b128 v7, v[36:39] offset:1024
s_waitcnt vmcnt(6)
ds_write_b128 v7, v[40:43] offset:2048
s_waitcnt vmcnt(5)
ds_write_b128 v7, v[44:47] offset:3072
s_waitcnt vmcnt(4)
ds_write_b128 v7, v[48:51] offset:4096
s_waitcnt vmcnt(3)
ds_write_b128 v7, v[52:55] offset:5120
s_waitcnt vmcnt(2)
ds_write_b128 v7, v[56:59] offset:6144
s_waitcnt vmcnt(1)
ds_write_b128 v7, v[60:63] offset:7168
s_waitcnt vmcnt(0)
ds_write_b128 v7, v[64:67] offset:8192
v_lshl_add_u32 v2, v4, 1, v8
s_waitcnt lgkmcnt(0)
ds_read_u16 v72, v2 offset:0
ds_read_u16 v73, v2 offset:288
ds_read_u16 v74, v2 offset:576
ds_read_u16 v75, v2 offset:864
ds_read_u16 v76, v2 offset:1152
ds_read_u16 v77, v2 offset:1440
ds_read_u16 v78, v2 offset:1728
ds_read_u16 v79, v2 offset:2016
s_waitcnt lgkmcnt(0)
v_lshl_or_b32 v32, v73, 16, v72
v_lshl_or_b32 v33, v75, 16, v74
v_lshl_or_b32 v34, v77, 16, v76
v_lshl_or_b32 v35, v79, 16, v78
ds_read_u16 v72, v2 offset:32
ds_read_u16 v73, v2 offset:320
ds_read_u16 v74, v2 offset:608
ds_read_u16 v75, v2 offset:896
ds_read_u16 v76, v2 offset:1184
ds_read_u16 v77, v2 offset:1472
ds_read_u16 v78, v2 offset:1760
ds_read_u16 v79, v2 offset:2048
s_waitcnt lgkmcnt(0)
v_lshl_or_b32 v36, v73, 16, v72
v_lshl_or_b32 v37, v75, 16, v74
v_lshl_or_b32 v38, v77, 16, v76
v_lshl_or_b32 v39, v79, 16, v78
ds_read_u16 v72, v2 offset:64
ds_read_u16 v73, v2 offset:352
ds_read_u16 v74, v2 offset:640
ds_read_u16 v75, v2 offset:928
ds_read_u16 v76, v2 offset:1216
ds_read_u16 v77, v2 offset:1504
ds_read_u16 v78, v2 offset:1792
ds_read_u16 v79, v2 offset:2080
s_waitcnt lgkmcnt(0)
v_lshl_or_b32 v40, v73, 16, v72
v_lshl_or_b32 v41, v75, 16, v74
v_lshl_or_b32 v42, v77, 16, v76
v_lshl_or_b32 v43, v79, 16, v78
ds_read_u16 v72, v2 offset:96
ds_read_u16 v73, v2 offset:384
ds_read_u16 v74, v2 offset:672
ds_read_u16 v75, v2 offset:960
ds_read_u16 v76, v2 offset:1248
ds_read_u16 v77, v2 offset:1536
ds_read_u16 v78, v2 offset:1824
ds_read_u16 v79, v2 offset:2112
s_waitcnt lgkmcnt(0)
v_lshl_or_b32 v44, v73, 16, v72
v_lshl_or_b32 v45, v75, 16, v74
v_lshl_or_b32 v46, v77, 16, v76
v_lshl_or_b32 v47, v79, 16, v78
ds_read_u16 v72, v2 offset:128
ds_read_u16 v73, v2 offset:416
ds_read_u16 v74, v2 offset:704
ds_read_u16 v75, v2 offset:992
ds_read_u16 v76, v2 offset:1280
ds_read_u16 v77, v2 offset:1568
ds_read_u16 v78, v2 offset:1856
ds_read_u16 v79, v2 offset:2144
s_waitcnt lgkmcnt(0)
v_lshl_or_b32 v48, v73, 16, v72
v_lshl_or_b32 v49, v75, 16, v74
v_lshl_or_b32 v50, v77, 16, v76
v_lshl_or_b32 v51, v79, 16, v78
ds_read_u16 v72, v2 offset:160
ds_read_u16 v73, v2 offset:448
ds_read_u16 v74, v2 offset:736
ds_read_u16 v75, v2 offset:1024
ds_read_u16 v76, v2 offset:1312
ds_read_u16 v77, v2 offset:1600
ds_read_u16 v78, v2 offset:1888
ds_read_u16 v79, v2 offset:2176
s_waitcnt lgkmcnt(0)
v_lshl_or_b32 v52, v73, 16, v72
v_lshl_or_b32 v53, v75, 16, v74
v_lshl_or_b32 v54, v77, 16, v76
v_lshl_or_b32 v55, v79, 16, v78
ds_read_u16 v72, v2 offset:192
ds_read_u16 v73, v2 offset:480
ds_read_u16 v74, v2 offset:768
ds_read_u16 v75, v2 offset:1056
ds_read_u16 v76, v2 offset:1344
ds_read_u16 v77, v2 offset:1632
ds_read_u16 v78, v2 offset:1920
ds_read_u16 v79, v2 offset:2208
s_waitcnt lgkmcnt(0)
v_lshl_or_b32 v56, v73, 16, v72
v_lshl_or_b32 v57, v75, 16, v74
v_lshl_or_b32 v58, v77, 16, v76
v_lshl_or_b32 v59, v79, 16, v78
ds_read_u16 v72, v2 offset:224
ds_read_u16 v73, v2 offset:512
ds_read_u16 v74, v2 offset:800
ds_read_u16 v75, v2 offset:1088
ds_read_u16 v76, v2 offset:1376
ds_read_u16 v77, v2 offset:1664
ds_read_u16 v78, v2 offset:1952
ds_read_u16 v79, v2 offset:2240
s_waitcnt lgkmcnt(0)
v_lshl_or_b32 v60, v73, 16, v72
v_lshl_or_b32 v61, v75, 16, v74
v_lshl_or_b32 v62, v77, 16, v76
v_lshl_or_b32 v63, v79, 16, v78
ds_read_u16 v72, v2 offset:256
ds_read_u16 v73, v2 offset:544
ds_read_u16 v74, v2 offset:832
ds_read_u16 v75, v2 offset:1120
ds_read_u16 v76, v2 offset:1408
ds_read_u16 v77, v2 offset:1696
ds_read_u16 v78, v2 offset:1984
ds_read_u16 v79, v2 offset:2272
s_waitcnt lgkmcnt(0)
v_lshl_or_b32 v64, v73, 16, v72
v_lshl_or_b32 v65, v75, 16, v74
v_lshl_or_b32 v66, v77, 16, v76
v_lshl_or_b32 v67, v79, 16, v78
s_mul_i32 s30, s28, 162
s_add_u32 s30, s30, s25
s_lshl_b32 s30, s30, 10
s_waitcnt lgkmcnt(0)
s_add_u32 s33, s30, 0
buffer_store_dwordx4 v[32:35], v6, s[12:15], s33 offen sc0 sc1
s_add_u32 s33, s30, 18432
buffer_store_dwordx4 v[36:39], v6, s[12:15], s33 offen sc0 sc1
s_add_u32 s33, s30, 36864
buffer_store_dwordx4 v[40:43], v6, s[12:15], s33 offen sc0 sc1
s_add_u32 s33, s30, 55296
buffer_store_dwordx4 v[44:47], v6, s[12:15], s33 offen sc0 sc1
s_add_u32 s33, s30, 73728
buffer_store_dwordx4 v[48:51], v6, s[12:15], s33 offen sc0 sc1
s_add_u32 s33, s30, 92160
buffer_store_dwordx4 v[52:55], v6, s[12:15], s33 offen sc0 sc1
s_add_u32 s33, s30, 110592
buffer_store_dwordx4 v[56:59], v6, s[12:15], s33 offen sc0 sc1
s_add_u32 s33, s30, 129024
buffer_store_dwordx4 v[60:63], v6, s[12:15], s33 offen sc0 sc1
s_add_u32 s33, s30, 147456
buffer_store_dwordx4 v[64:67], v6, s[12:15], s33 offen sc0 sc1
s_mov_b64 exec, -1
s_branch k2_exit
kf_task_done:
s_load_dwordx2 s[6:7], s[0:1], 80
s_load_dwordx2 s[20:21], s[0:1], 88
v_lshrrev_b32 v1, 6, v0
s_nop 0
v_readfirstlane_b32 s22, v1
s_waitcnt vmcnt(0) lgkmcnt(0)
s_mov_b32 s48, s6
s_mov_b32 s49, s7
s_mov_b32 s50, 0x100
s_mov_b32 s51, 0x00020000
s_cmp_ge_u32 s2, 154
s_cbranch_scc1 kf_nosig
s_barrier
s_cmp_lg_u32 s22, 0
s_cbranch_scc1 kf_nosig
s_mov_b64 exec, 1
s_and_b32 s26, s2, 0
s_lshl_b32 s26, s26, 6
v_mov_b32 v1, s26
v_mov_b32 v2, 1
buffer_atomic_add v2, v1, s[48:51], 0 offen sc0 sc1
s_waitcnt vmcnt(0)
v_readfirstlane_b32 s26, v2
s_nop 0
s_cmp_lg_u32 s26, 153
s_cbranch_scc1 kf_notlast
v_mov_b32 v1, 128
v_mov_b32 v2, 1
buffer_store_dword v2, v1, s[48:51], 0 offen sc0 sc1
kf_notlast:
s_mov_b64 exec, -1
kf_nosig:
s_and_b32 s25, s2, 7
s_lshr_b32 s26, s2, 3
s_lshr_b32 s24, s25, 1
s_lshl_b32 s24, s24, 3
s_and_b32 s27, s26, 7
s_add_u32 s24, s24, s27
s_and_b32 s23, s25, 1
s_lshl_b32 s23, s23, 2
s_lshr_b32 s27, s26, 3
s_add_u32 s23, s23, s27
s_cmp_lg_u32 s22, 0
s_cbranch_scc1 kf_nopoll
v_mov_b32 v1, 128
s_mov_b32 s29, 20000
kf_poll:
buffer_load_dword v2, v1, s[48:51], 0 offen sc0 sc1
s_waitcnt vmcnt(0)
v_readfirstlane_b32 s26, v2
s_sub_u32 s29, s29, 1
s_cmp_eq_u32 s29, 0
s_cbranch_scc1 kf_nopoll
s_cmp_eq_u32 s26, 0
s_cbranch_scc1 kf_poll
kf_nopoll:
s_barrier
v_and_b32 v1, 63, v0
v_and_b32 v2, 15, v1
v_lshrrev_b32 v3, 4, v1
v_lshlrev_b32 v4, 4, v1
s_lshl_b32 s25, s23, 3
s_add_u32 s25, s25, s22
s_lshr_b32 s26, s22, 1
s_and_b32 s27, s22, 1
s_waitcnt lgkmcnt(0)
s_add_u32 s8, s20, 0x3400000
s_addc_u32 s9, s21, 0
s_mov_b32 s10, 0x240000
s_mov_b32 s11, 0x00020000
s_mov_b32 s12, s20
s_mov_b32 s13, s21
s_mov_b32 s14, 0x1200
s_mov_b32 s15, 0x00020000
s_add_u32 s16, s20, 0x10000
s_addc_u32 s17, s21, 0
s_mov_b32 s18, 0x1e6000
s_mov_b32 s19, 0x00020000
s_mul_i32 s28, s27, 1152
buffer_load_dwordx4 v[132:135], v4, s[12:15], s28 offen sc1
buffer_load_dwordx4 v[136:139], v4, s[12:15], s28 offen offset:1024 sc1
s_add_u32 s28, s28, 2304
buffer_load_dwordx4 v[140:143], v4, s[12:15], s28 offen sc1
buffer_load_dwordx4 v[144:147], v4, s[12:15], s28 offen offset:1024 sc1
s_mul_i32 s28, s24, 73728
s_mul_i32 s29, s27, 36864
s_add_u32 s28, s28, s29
s_lshl_b32 s29, s26, 10
s_add_u32 s28, s28, s29
buffer_load_dwordx4 v[16:19], v4, s[8:11], s28 offen sc1
s_add_u32 s28, s28, 4096
buffer_load_dwordx4 v[20:23], v4, s[8:11], s28 offen sc1
s_add_u32 s28, s28, 4096
buffer_load_dwordx4 v[24:27], v4, s[8:11], s28 offen sc1
s_add_u32 s28, s28, 4096
buffer_load_dwordx4 v[28:31], v4, s[8:11], s28 offen sc1
s_add_u32 s28, s28, 4096
buffer_load_dwordx4 v[32:35], v4, s[8:11], s28 offen sc1
s_add_u32 s28, s28, 4096
buffer_load_dwordx4 v[36:39], v4, s[8:11], s28 offen sc1
s_add_u32 s28, s28, 4096
buffer_load_dwordx4 v[40:43], v4, s[8:11], s28 offen sc1
s_add_u32 s28, s28, 4096
buffer_load_dwordx4 v[44:47], v4, s[8:11], s28 offen sc1
s_add_u32 s28, s28, 4096
buffer_load_dwordx4 v[48:51], v4, s[8:11], s28 offen sc1
s_mul_i32 s40, s25, 36864
s_lshl_b32 s28, s22, 12
s_add_u32 s33, s28, 73728
v_add_u32 v6, s33, v4
s_waitcnt vmcnt(9)
ds_write_b128 v6, v[132:135] offset:0
ds_write_b128 v6, v[136:139] offset:1024
ds_write_b128 v6, v[140:143] offset:2048
ds_write_b128 v6, v[144:147] offset:3072
s_waitcnt lgkmcnt(0)
v_lshlrev_b32 v8, 5, v3
v_add_u32 v8, s33, v8
s_mul_i32 s28, s27, 36864
s_lshl_b32 s29, s26, 10
s_add_u32 s28, s28, s29
v_add_u32 v9, s28, v4
ds_read_b128 v[108:111], v8 offset:0
ds_read_b128 v[112:115], v8 offset:16
ds_read_b128 v[100:103], v8 offset:2048
ds_read_b128 v[104:107], v8 offset:2064
ds_read_b128 v[124:127], v8 offset:128
ds_read_b128 v[128:131], v8 offset:144
ds_read_b128 v[116:119], v8 offset:2176
ds_read_b128 v[120:123], v8 offset:2192
s_waitcnt vmcnt(8) lgkmcnt(4)
v_lshlrev_b32 v132, 16, v16
v_and_b32 v133, 0xffff0000, v16
v_lshlrev_b32 v134, 16, v17
v_and_b32 v135, 0xffff0000, v17
v_lshlrev_b32 v136, 16, v18
v_and_b32 v137, 0xffff0000, v18
v_lshlrev_b32 v138, 16, v19
v_and_b32 v139, 0xffff0000, v19
v_pk_fma_f32 v[132:133], v[132:133], v[100:101], v[108:109]
v_pk_fma_f32 v[134:135], v[134:135], v[102:103], v[110:111]
v_pk_fma_f32 v[136:137], v[136:137], v[104:105], v[112:113]
v_pk_fma_f32 v[138:139], v[138:139], v[106:107], v[114:115]
v_cvt_pk_bf16_f32 v140, v132, v133
v_cvt_pk_bf16_f32 v141, v134, v135
v_cvt_pk_bf16_f32 v142, v136, v137
v_cvt_pk_bf16_f32 v143, v138, v139
ds_write_b128 v9, v[140:143] offset:0
buffer_load_dwordx4 v[52:55], v4, s[16:19], s40 offen offset:0 sc1
ds_read_b128 v[108:111], v8 offset:256
ds_read_b128 v[112:115], v8 offset:272
ds_read_b128 v[100:103], v8 offset:2304
ds_read_b128 v[104:107], v8 offset:2320
s_waitcnt vmcnt(8) lgkmcnt(4)
v_lshlrev_b32 v132, 16, v20
v_and_b32 v133, 0xffff0000, v20
v_lshlrev_b32 v134, 16, v21
v_and_b32 v135, 0xffff0000, v21
v_lshlrev_b32 v136, 16, v22
v_and_b32 v137, 0xffff0000, v22
v_lshlrev_b32 v138, 16, v23
v_and_b32 v139, 0xffff0000, v23
v_pk_fma_f32 v[132:133], v[132:133], v[116:117], v[124:125]
v_pk_fma_f32 v[134:135], v[134:135], v[118:119], v[126:127]
v_pk_fma_f32 v[136:137], v[136:137], v[120:121], v[128:129]
v_pk_fma_f32 v[138:139], v[138:139], v[122:123], v[130:131]
v_cvt_pk_bf16_f32 v144, v132, v133
v_cvt_pk_bf16_f32 v145, v134, v135
v_cvt_pk_bf16_f32 v146, v136, v137
v_cvt_pk_bf16_f32 v147, v138, v139
ds_write_b128 v9, v[144:147] offset:4096
buffer_load_dwordx4 v[56:59], v4, s[16:19], s40 offen offset:1024 sc1
s_add_u32 s40, s40, 2048
ds_read_b128 v[124:127], v8 offset:384
ds_read_b128 v[128:131], v8 offset:400
ds_read_b128 v[116:119], v8 offset:2432
ds_read_b128 v[120:123], v8 offset:2448
s_waitcnt vmcnt(8) lgkmcnt(4)
v_lshlrev_b32 v132, 16, v24
v_and_b32 v133, 0xffff0000, v24
v_lshlrev_b32 v134, 16, v25
v_and_b32 v135, 0xffff0000, v25
v_lshlrev_b32 v136, 16, v26
v_and_b32 v137, 0xffff0000, v26
v_lshlrev_b32 v138, 16, v27
v_and_b32 v139, 0xffff0000, v27
v_pk_fma_f32 v[132:133], v[132:133], v[100:101], v[108:109]
v_pk_fma_f32 v[134:135], v[134:135], v[102:103], v[110:111]
v_pk_fma_f32 v[136:137], v[136:137], v[104:105], v[112:113]
v_pk_fma_f32 v[138:139], v[138:139], v[106:107], v[114:115]
v_cvt_pk_bf16_f32 v140, v132, v133
v_cvt_pk_bf16_f32 v141, v134, v135
v_cvt_pk_bf16_f32 v142, v136, v137
v_cvt_pk_bf16_f32 v143, v138, v139
ds_write_b128 v9, v[140:143] offset:8192
buffer_load_dwordx4 v[60:63], v4, s[16:19], s40 offen offset:0 sc1
ds_read_b128 v[108:111], v8 offset:512
ds_read_b128 v[112:115], v8 offset:528
ds_read_b128 v[100:103], v8 offset:2560
ds_read_b128 v[104:107], v8 offset:2576
s_waitcnt vmcnt(8) lgkmcnt(4)
v_lshlrev_b32 v132, 16, v28
v_and_b32 v133, 0xffff0000, v28
v_lshlrev_b32 v134, 16, v29
v_and_b32 v135, 0xffff0000, v29
v_lshlrev_b32 v136, 16, v30
v_and_b32 v137, 0xffff0000, v30
v_lshlrev_b32 v138, 16, v31
v_and_b32 v139, 0xffff0000, v31
v_pk_fma_f32 v[132:133], v[132:133], v[116:117], v[124:125]
v_pk_fma_f32 v[134:135], v[134:135], v[118:119], v[126:127]
v_pk_fma_f32 v[136:137], v[136:137], v[120:121], v[128:129]
v_pk_fma_f32 v[138:139], v[138:139], v[122:123], v[130:131]
v_cvt_pk_bf16_f32 v144, v132, v133
v_cvt_pk_bf16_f32 v145, v134, v135
v_cvt_pk_bf16_f32 v146, v136, v137
v_cvt_pk_bf16_f32 v147, v138, v139
ds_write_b128 v9, v[144:147] offset:12288
buffer_load_dwordx4 v[64:67], v4, s[16:19], s40 offen offset:1024 sc1
s_add_u32 s40, s40, 2048
ds_read_b128 v[124:127], v8 offset:640
ds_read_b128 v[128:131], v8 offset:656
ds_read_b128 v[116:119], v8 offset:2688
ds_read_b128 v[120:123], v8 offset:2704
s_waitcnt vmcnt(8) lgkmcnt(4)
v_lshlrev_b32 v132, 16, v32
v_and_b32 v133, 0xffff0000, v32
v_lshlrev_b32 v134, 16, v33
v_and_b32 v135, 0xffff0000, v33
v_lshlrev_b32 v136, 16, v34
v_and_b32 v137, 0xffff0000, v34
v_lshlrev_b32 v138, 16, v35
v_and_b32 v139, 0xffff0000, v35
v_pk_fma_f32 v[132:133], v[132:133], v[100:101], v[108:109]
v_pk_fma_f32 v[134:135], v[134:135], v[102:103], v[110:111]
v_pk_fma_f32 v[136:137], v[136:137], v[104:105], v[112:113]
v_pk_fma_f32 v[138:139], v[138:139], v[106:107], v[114:115]
v_cvt_pk_bf16_f32 v140, v132, v133
v_cvt_pk_bf16_f32 v141, v134, v135
v_cvt_pk_bf16_f32 v142, v136, v137
v_cvt_pk_bf16_f32 v143, v138, v139
ds_write_b128 v9, v[140:143] offset:16384
buffer_load_dwordx4 v[68:71], v4, s[16:19], s40 offen offset:0 sc1
ds_read_b128 v[108:111], v8 offset:768
ds_read_b128 v[112:115], v8 offset:784
ds_read_b128 v[100:103], v8 offset:2816
ds_read_b128 v[104:107], v8 offset:2832
s_waitcnt vmcnt(8) lgkmcnt(4)
v_lshlrev_b32 v132, 16, v36
v_and_b32 v133, 0xffff0000, v36
v_lshlrev_b32 v134, 16, v37
v_and_b32 v135, 0xffff0000, v37
v_lshlrev_b32 v136, 16, v38
v_and_b32 v137, 0xffff0000, v38
v_lshlrev_b32 v138, 16, v39
v_and_b32 v139, 0xffff0000, v39
v_pk_fma_f32 v[132:133], v[132:133], v[116:117], v[124:125]
v_pk_fma_f32 v[134:135], v[134:135], v[118:119], v[126:127]
v_pk_fma_f32 v[136:137], v[136:137], v[120:121], v[128:129]
v_pk_fma_f32 v[138:139], v[138:139], v[122:123], v[130:131]
v_cvt_pk_bf16_f32 v144, v132, v133
v_cvt_pk_bf16_f32 v145, v134, v135
v_cvt_pk_bf16_f32 v146, v136, v137
v_cvt_pk_bf16_f32 v147, v138, v139
ds_write_b128 v9, v[144:147] offset:20480
buffer_load_dwordx4 v[72:75], v4, s[16:19], s40 offen offset:1024 sc1
s_add_u32 s40, s40, 2048
ds_read_b128 v[124:127], v8 offset:896
ds_read_b128 v[128:131], v8 offset:912
ds_read_b128 v[116:119], v8 offset:2944
ds_read_b128 v[120:123], v8 offset:2960
s_waitcnt vmcnt(8) lgkmcnt(4)
v_lshlrev_b32 v132, 16, v40
v_and_b32 v133, 0xffff0000, v40
v_lshlrev_b32 v134, 16, v41
v_and_b32 v135, 0xffff0000, v41
v_lshlrev_b32 v136, 16, v42
v_and_b32 v137, 0xffff0000, v42
v_lshlrev_b32 v138, 16, v43
v_and_b32 v139, 0xffff0000, v43
v_pk_fma_f32 v[132:133], v[132:133], v[100:101], v[108:109]
v_pk_fma_f32 v[134:135], v[134:135], v[102:103], v[110:111]
v_pk_fma_f32 v[136:137], v[136:137], v[104:105], v[112:113]
v_pk_fma_f32 v[138:139], v[138:139], v[106:107], v[114:115]
v_cvt_pk_bf16_f32 v140, v132, v133
v_cvt_pk_bf16_f32 v141, v134, v135
v_cvt_pk_bf16_f32 v142, v136, v137
v_cvt_pk_bf16_f32 v143, v138, v139
ds_write_b128 v9, v[140:143] offset:24576
buffer_load_dwordx4 v[76:79], v4, s[16:19], s40 offen offset:0 sc1
ds_read_b128 v[108:111], v8 offset:1024
ds_read_b128 v[112:115], v8 offset:1040
ds_read_b128 v[100:103], v8 offset:3072
ds_read_b128 v[104:107], v8 offset:3088
s_waitcnt vmcnt(8) lgkmcnt(4)
v_lshlrev_b32 v132, 16, v44
v_and_b32 v133, 0xffff0000, v44
v_lshlrev_b32 v134, 16, v45
v_and_b32 v135, 0xffff0000, v45
v_lshlrev_b32 v136, 16, v46
v_and_b32 v137, 0xffff0000, v46
v_lshlrev_b32 v138, 16, v47
v_and_b32 v139, 0xffff0000, v47
v_pk_fma_f32 v[132:133], v[132:133], v[116:117], v[124:125]
v_pk_fma_f32 v[134:135], v[134:135], v[118:119], v[126:127]
v_pk_fma_f32 v[136:137], v[136:137], v[120:121], v[128:129]
v_pk_fma_f32 v[138:139], v[138:139], v[122:123], v[130:131]
v_cvt_pk_bf16_f32 v144, v132, v133
v_cvt_pk_bf16_f32 v145, v134, v135
v_cvt_pk_bf16_f32 v146, v136, v137
v_cvt_pk_bf16_f32 v147, v138, v139
ds_write_b128 v9, v[144:147] offset:28672
buffer_load_dwordx4 v[80:83], v4, s[16:19], s40 offen offset:1024 sc1
s_add_u32 s40, s40, 2048
s_waitcnt vmcnt(8) lgkmcnt(0)
v_lshlrev_b32 v132, 16, v48
v_and_b32 v133, 0xffff0000, v48
v_lshlrev_b32 v134, 16, v49
v_and_b32 v135, 0xffff0000, v49
v_lshlrev_b32 v136, 16, v50
v_and_b32 v137, 0xffff0000, v50
v_lshlrev_b32 v138, 16, v51
v_and_b32 v139, 0xffff0000, v51
v_pk_fma_f32 v[132:133], v[132:133], v[100:101], v[108:109]
v_pk_fma_f32 v[134:135], v[134:135], v[102:103], v[110:111]
v_pk_fma_f32 v[136:137], v[136:137], v[104:105], v[112:113]
v_pk_fma_f32 v[138:139], v[138:139], v[106:107], v[114:115]
v_cvt_pk_bf16_f32 v140, v132, v133
v_cvt_pk_bf16_f32 v141, v134, v135
v_cvt_pk_bf16_f32 v142, v136, v137
v_cvt_pk_bf16_f32 v143, v138, v139
ds_write_b128 v9, v[140:143] offset:32768
buffer_load_dwordx4 v[84:87], v4, s[16:19], s40 offen offset:0 sc1
buffer_load_dwordx4 v[88:91], v4, s[16:19], s40 offen offset:1024 sc1
s_add_u32 s40, s40, 2048
buffer_load_dwordx4 v[92:95], v4, s[16:19], s40 offen offset:0 sc1
buffer_load_dwordx4 v[96:99], v4, s[16:19], s40 offen offset:1024 sc1
s_add_u32 s40, s40, 2048
s_waitcnt lgkmcnt(0)
s_barrier
s_cmp_ge_u32 s25, 54
s_cbranch_scc1 k2_exit
s_cmp_ge_u32 s25, 52
s_cbranch_scc1 k2_gv
s_cmp_ge_u32 s25, 48
s_cbranch_scc1 k2_gq
s_cmp_ge_u32 s25, 32
s_cbranch_scc1 k2_gv
k2_gq:
s_mov_b32 s41, s40
v_add_u32 v10, 0x10000, v4
ds_read_b128 v[16:19], v4 offset:0
ds_read_b128 v[20:23], v4 offset:1024
ds_read_b128 v[24:27], v4 offset:2048
ds_read_b128 v[28:31], v4 offset:3072
ds_read_b128 v[32:35], v4 offset:4096
ds_read_b128 v[36:39], v4 offset:5120
ds_read_b128 v[40:43], v4 offset:6144
ds_read_b128 v[44:47], v4 offset:7168
s_waitcnt vmcnt(10) lgkmcnt(4)
v_mfma_f32_16x16x32_bf16 v[100:103], v[52:55], v[16:19], 0
v_mfma_f32_16x16x32_bf16 v[104:107], v[52:55], v[20:23], 0
v_mfma_f32_16x16x32_bf16 v[108:111], v[52:55], v[24:27], 0
v_mfma_f32_16x16x32_bf16 v[112:115], v[52:55], v[28:31], 0
buffer_load_dwordx4 v[52:55], v4, s[16:19], s41 offen offset:0 sc1
v_mfma_f32_16x16x32_bf16 v[116:119], v[56:59], v[16:19], 0
v_mfma_f32_16x16x32_bf16 v[120:123], v[56:59], v[20:23], 0
v_mfma_f32_16x16x32_bf16 v[124:127], v[56:59], v[24:27], 0
v_mfma_f32_16x16x32_bf16 v[128:131], v[56:59], v[28:31], 0
buffer_load_dwordx4 v[56:59], v4, s[16:19], s41 offen offset:1024 sc1
s_add_u32 s41, s41, 2048
ds_read_b128 v[16:19], v4 offset:8192
ds_read_b128 v[20:23], v4 offset:9216
ds_read_b128 v[24:27], v4 offset:10240
ds_read_b128 v[28:31], v4 offset:11264
s_waitcnt vmcnt(10) lgkmcnt(4)
v_mfma_f32_16x16x32_bf16 v[100:103], v[60:63], v[32:35], v[100:103]
v_mfma_f32_16x16x32_bf16 v[104:107], v[60:63], v[36:39], v[104:107]
v_mfma_f32_16x16x32_bf16 v[108:111], v[60:63], v[40:43], v[108:111]
v_mfma_f32_16x16x32_bf16 v[112:115], v[60:63], v[44:47], v[112:115]
buffer_load_dwordx4 v[60:63], v4, s[16:19], s41 offen offset:0 sc1
v_mfma_f32_16x16x32_bf16 v[116:119], v[64:67], v[32:35], v[116:119]
v_mfma_f32_16x16x32_bf16 v[120:123], v[64:67], v[36:39], v[120:123]
v_mfma_f32_16x16x32_bf16 v[124:127], v[64:67], v[40:43], v[124:127]
v_mfma_f32_16x16x32_bf16 v[128:131], v[64:67], v[44:47], v[128:131]
buffer_load_dwordx4 v[64:67], v4, s[16:19], s41 offen offset:1024 sc1
s_add_u32 s41, s41, 2048
ds_read_b128 v[32:35], v4 offset:12288
ds_read_b128 v[36:39], v4 offset:13312
ds_read_b128 v[40:43], v4 offset:14336
ds_read_b128 v[44:47], v4 offset:15360
s_waitcnt vmcnt(10) lgkmcnt(4)
v_mfma_f32_16x16x32_bf16 v[100:103], v[68:71], v[16:19], v[100:103]
v_mfma_f32_16x16x32_bf16 v[104:107], v[68:71], v[20:23], v[104:107]
v_mfma_f32_16x16x32_bf16 v[108:111], v[68:71], v[24:27], v[108:111]
v_mfma_f32_16x16x32_bf16 v[112:115], v[68:71], v[28:31], v[112:115]
buffer_load_dwordx4 v[68:71], v4, s[16:19], s41 offen offset:0 sc1
v_mfma_f32_16x16x32_bf16 v[116:119], v[72:75], v[16:19], v[116:119]
v_mfma_f32_16x16x32_bf16 v[120:123], v[72:75], v[20:23], v[120:123]
v_mfma_f32_16x16x32_bf16 v[124:127], v[72:75], v[24:27], v[124:127]
v_mfma_f32_16x16x32_bf16 v[128:131], v[72:75], v[28:31], v[128:131]
buffer_load_dwordx4 v[72:75], v4, s[16:19], s41 offen offset:1024 sc1
s_add_u32 s41, s41, 2048
ds_read_b128 v[16:19], v4 offset:16384
ds_read_b128 v[20:23], v4 offset:17408
ds_read_b128 v[24:27], v4 offset:18432
ds_read_b128 v[28:31], v4 offset:19456
s_waitcnt vmcnt(10) lgkmcnt(4)
v_mfma_f32_16x16x32_bf16 v[100:103], v[76:79], v[32:35], v[100:103]
v_mfma_f32_16x16x32_bf16 v[104:107], v[76:79], v[36:39], v[104:107]
v_mfma_f32_16x16x32_bf16 v[108:111], v[76:79], v[40:43], v[108:111]
v_mfma_f32_16x16x32_bf16 v[112:115], v[76:79], v[44:47], v[112:115]
buffer_load_dwordx4 v[76:79], v4, s[16:19], s41 offen offset:0 sc1
v_mfma_f32_16x16x32_bf16 v[116:119], v[80:83], v[32:35], v[116:119]
v_mfma_f32_16x16x32_bf16 v[120:123], v[80:83], v[36:39], v[120:123]
v_mfma_f32_16x16x32_bf16 v[124:127], v[80:83], v[40:43], v[124:127]
v_mfma_f32_16x16x32_bf16 v[128:131], v[80:83], v[44:47], v[128:131]
buffer_load_dwordx4 v[80:83], v4, s[16:19], s41 offen offset:1024 sc1
s_add_u32 s41, s41, 2048
ds_read_b128 v[32:35], v4 offset:20480
ds_read_b128 v[36:39], v4 offset:21504
ds_read_b128 v[40:43], v4 offset:22528
ds_read_b128 v[44:47], v4 offset:23552
s_waitcnt vmcnt(10) lgkmcnt(4)
v_mfma_f32_16x16x32_bf16 v[100:103], v[84:87], v[16:19], v[100:103]
v_mfma_f32_16x16x32_bf16 v[104:107], v[84:87], v[20:23], v[104:107]
v_mfma_f32_16x16x32_bf16 v[108:111], v[84:87], v[24:27], v[108:111]
v_mfma_f32_16x16x32_bf16 v[112:115], v[84:87], v[28:31], v[112:115]
buffer_load_dwordx4 v[84:87], v4, s[16:19], s41 offen offset:0 sc1
v_mfma_f32_16x16x32_bf16 v[116:119], v[88:91], v[16:19], v[116:119]
v_mfma_f32_16x16x32_bf16 v[120:123], v[88:91], v[20:23], v[120:123]
v_mfma_f32_16x16x32_bf16 v[124:127], v[88:91], v[24:27], v[124:127]
v_mfma_f32_16x16x32_bf16 v[128:131], v[88:91], v[28:31], v[128:131]
buffer_load_dwordx4 v[88:91], v4, s[16:19], s41 offen offset:1024 sc1
s_add_u32 s41, s41, 2048
ds_read_b128 v[16:19], v4 offset:24576
ds_read_b128 v[20:23], v4 offset:25600
ds_read_b128 v[24:27], v4 offset:26624
ds_read_b128 v[28:31], v4 offset:27648
s_waitcnt vmcnt(10) lgkmcnt(4)
v_mfma_f32_16x16x32_bf16 v[100:103], v[92:95], v[32:35], v[100:103]
v_mfma_f32_16x16x32_bf16 v[104:107], v[92:95], v[36:39], v[104:107]
v_mfma_f32_16x16x32_bf16 v[108:111], v[92:95], v[40:43], v[108:111]
v_mfma_f32_16x16x32_bf16 v[112:115], v[92:95], v[44:47], v[112:115]
buffer_load_dwordx4 v[92:95], v4, s[16:19], s41 offen offset:0 sc1
v_mfma_f32_16x16x32_bf16 v[116:119], v[96:99], v[32:35], v[116:119]
v_mfma_f32_16x16x32_bf16 v[120:123], v[96:99], v[36:39], v[120:123]
v_mfma_f32_16x16x32_bf16 v[124:127], v[96:99], v[40:43], v[124:127]
v_mfma_f32_16x16x32_bf16 v[128:131], v[96:99], v[44:47], v[128:131]
buffer_load_dwordx4 v[96:99], v4, s[16:19], s41 offen offset:1024 sc1
s_add_u32 s41, s41, 2048
ds_read_b128 v[32:35], v4 offset:28672
ds_read_b128 v[36:39], v4 offset:29696
ds_read_b128 v[40:43], v4 offset:30720
ds_read_b128 v[44:47], v4 offset:31744
s_waitcnt vmcnt(10) lgkmcnt(4)
v_mfma_f32_16x16x32_bf16 v[100:103], v[52:55], v[16:19], v[100:103]
v_mfma_f32_16x16x32_bf16 v[104:107], v[52:55], v[20:23], v[104:107]
v_mfma_f32_16x16x32_bf16 v[108:111], v[52:55], v[24:27], v[108:111]
v_mfma_f32_16x16x32_bf16 v[112:115], v[52:55], v[28:31], v[112:115]
buffer_load_dwordx4 v[52:55], v4, s[16:19], s41 offen offset:0 sc1
v_mfma_f32_16x16x32_bf16 v[116:119], v[56:59], v[16:19], v[116:119]
v_mfma_f32_16x16x32_bf16 v[120:123], v[56:59], v[20:23], v[120:123]
v_mfma_f32_16x16x32_bf16 v[124:127], v[56:59], v[24:27], v[124:127]
v_mfma_f32_16x16x32_bf16 v[128:131], v[56:59], v[28:31], v[128:131]
buffer_load_dwordx4 v[56:59], v4, s[16:19], s41 offen offset:1024 sc1
s_add_u32 s41, s41, 2048
ds_read_b128 v[16:19], v4 offset:32768
ds_read_b128 v[20:23], v4 offset:33792
ds_read_b128 v[24:27], v4 offset:34816
ds_read_b128 v[28:31], v4 offset:35840
s_waitcnt vmcnt(10) lgkmcnt(4)
v_mfma_f32_16x16x32_bf16 v[100:103], v[60:63], v[32:35], v[100:103]
v_mfma_f32_16x16x32_bf16 v[104:107], v[60:63], v[36:39], v[104:107]
v_mfma_f32_16x16x32_bf16 v[108:111], v[60:63], v[40:43], v[108:111]
v_mfma_f32_16x16x32_bf16 v[112:115], v[60:63], v[44:47], v[112:115]
buffer_load_dwordx4 v[60:63], v4, s[16:19], s41 offen offset:0 sc1
v_mfma_f32_16x16x32_bf16 v[116:119], v[64:67], v[32:35], v[116:119]
v_mfma_f32_16x16x32_bf16 v[120:123], v[64:67], v[36:39], v[120:123]
v_mfma_f32_16x16x32_bf16 v[124:127], v[64:67], v[40:43], v[124:127]
v_mfma_f32_16x16x32_bf16 v[128:131], v[64:67], v[44:47], v[128:131]
buffer_load_dwordx4 v[64:67], v4, s[16:19], s41 offen offset:1024 sc1
s_add_u32 s41, s41, 2048
ds_read_b128 v[32:35], v4 offset:36864
ds_read_b128 v[36:39], v4 offset:37888
ds_read_b128 v[40:43], v4 offset:38912
ds_read_b128 v[44:47], v4 offset:39936
s_waitcnt vmcnt(10) lgkmcnt(4)
v_mfma_f32_16x16x32_bf16 v[100:103], v[68:71], v[16:19], v[100:103]
v_mfma_f32_16x16x32_bf16 v[104:107], v[68:71], v[20:23], v[104:107]
v_mfma_f32_16x16x32_bf16 v[108:111], v[68:71], v[24:27], v[108:111]
v_mfma_f32_16x16x32_bf16 v[112:115], v[68:71], v[28:31], v[112:115]
buffer_load_dwordx4 v[68:71], v4, s[16:19], s41 offen offset:0 sc1
v_mfma_f32_16x16x32_bf16 v[116:119], v[72:75], v[16:19], v[116:119]
v_mfma_f32_16x16x32_bf16 v[120:123], v[72:75], v[20:23], v[120:123]
v_mfma_f32_16x16x32_bf16 v[124:127], v[72:75], v[24:27], v[124:127]
v_mfma_f32_16x16x32_bf16 v[128:131], v[72:75], v[28:31], v[128:131]
buffer_load_dwordx4 v[72:75], v4, s[16:19], s41 offen offset:1024 sc1
s_add_u32 s41, s41, 2048
ds_read_b128 v[16:19], v4 offset:40960
ds_read_b128 v[20:23], v4 offset:41984
ds_read_b128 v[24:27], v4 offset:43008
ds_read_b128 v[28:31], v4 offset:44032
s_waitcnt vmcnt(10) lgkmcnt(4)
v_mfma_f32_16x16x32_bf16 v[100:103], v[76:79], v[32:35], v[100:103]
v_mfma_f32_16x16x32_bf16 v[104:107], v[76:79], v[36:39], v[104:107]
v_mfma_f32_16x16x32_bf16 v[108:111], v[76:79], v[40:43], v[108:111]
v_mfma_f32_16x16x32_bf16 v[112:115], v[76:79], v[44:47], v[112:115]
buffer_load_dwordx4 v[76:79], v4, s[16:19], s41 offen offset:0 sc1
v_mfma_f32_16x16x32_bf16 v[116:119], v[80:83], v[32:35], v[116:119]
v_mfma_f32_16x16x32_bf16 v[120:123], v[80:83], v[36:39], v[120:123]
v_mfma_f32_16x16x32_bf16 v[124:127], v[80:83], v[40:43], v[124:127]
v_mfma_f32_16x16x32_bf16 v[128:131], v[80:83], v[44:47], v[128:131]
buffer_load_dwordx4 v[80:83], v4, s[16:19], s41 offen offset:1024 sc1
s_add_u32 s41, s41, 2048
ds_read_b128 v[32:35], v4 offset:45056
ds_read_b128 v[36:39], v4 offset:46080
ds_read_b128 v[40:43], v4 offset:47104
ds_read_b128 v[44:47], v4 offset:48128
s_waitcnt vmcnt(10) lgkmcnt(4)
v_mfma_f32_16x16x32_bf16 v[100:103], v[84:87], v[16:19], v[100:103]
v_mfma_f32_16x16x32_bf16 v[104:107], v[84:87], v[20:23], v[104:107]
v_mfma_f32_16x16x32_bf16 v[108:111], v[84:87], v[24:27], v[108:111]
v_mfma_f32_16x16x32_bf16 v[112:115], v[84:87], v[28:31], v[112:115]
buffer_load_dwordx4 v[84:87], v4, s[16:19], s41 offen offset:0 sc1
v_mfma_f32_16x16x32_bf16 v[116:119], v[88:91], v[16:19], v[116:119]
v_mfma_f32_16x16x32_bf16 v[120:123], v[88:91], v[20:23], v[120:123]
v_mfma_f32_16x16x32_bf16 v[124:127], v[88:91], v[24:27], v[124:127]
v_mfma_f32_16x16x32_bf16 v[128:131], v[88:91], v[28:31], v[128:131]
buffer_load_dwordx4 v[88:91], v4, s[16:19], s41 offen offset:1024 sc1
s_add_u32 s41, s41, 2048
ds_read_b128 v[16:19], v4 offset:49152
ds_read_b128 v[20:23], v4 offset:50176
ds_read_b128 v[24:27], v4 offset:51200
ds_read_b128 v[28:31], v4 offset:52224
s_waitcnt vmcnt(10) lgkmcnt(4)
v_mfma_f32_16x16x32_bf16 v[100:103], v[92:95], v[32:35], v[100:103]
v_mfma_f32_16x16x32_bf16 v[104:107], v[92:95], v[36:39], v[104:107]
v_mfma_f32_16x16x32_bf16 v[108:111], v[92:95], v[40:43], v[108:111]
v_mfma_f32_16x16x32_bf16 v[112:115], v[92:95], v[44:47], v[112:115]
buffer_load_dwordx4 v[92:95], v4, s[16:19], s41 offen offset:0 sc1
v_mfma_f32_16x16x32_bf16 v[116:119], v[96:99], v[32:35], v[116:119]
v_mfma_f32_16x16x32_bf16 v[120:123], v[96:99], v[36:39], v[120:123]
v_mfma_f32_16x16x32_bf16 v[124:127], v[96:99], v[40:43], v[124:127]
v_mfma_f32_16x16x32_bf16 v[128:131], v[96:99], v[44:47], v[128:131]
buffer_load_dwordx4 v[96:99], v4, s[16:19], s41 offen offset:1024 sc1
s_add_u32 s41, s41, 2048
ds_read_b128 v[32:35], v4 offset:53248
ds_read_b128 v[36:39], v4 offset:54272
ds_read_b128 v[40:43], v4 offset:55296
ds_read_b128 v[44:47], v4 offset:56320
s_waitcnt vmcnt(10) lgkmcnt(4)
v_mfma_f32_16x16x32_bf16 v[100:103], v[52:55], v[16:19], v[100:103]
v_mfma_f32_16x16x32_bf16 v[104:107], v[52:55], v[20:23], v[104:107]
v_mfma_f32_16x16x32_bf16 v[108:111], v[52:55], v[24:27], v[108:111]
v_mfma_f32_16x16x32_bf16 v[112:115], v[52:55], v[28:31], v[112:115]
v_mfma_f32_16x16x32_bf16 v[116:119], v[56:59], v[16:19], v[116:119]
v_mfma_f32_16x16x32_bf16 v[120:123], v[56:59], v[20:23], v[120:123]
v_mfma_f32_16x16x32_bf16 v[124:127], v[56:59], v[24:27], v[124:127]
v_mfma_f32_16x16x32_bf16 v[128:131], v[56:59], v[28:31], v[128:131]
ds_read_b128 v[16:19], v4 offset:57344
ds_read_b128 v[20:23], v4 offset:58368
ds_read_b128 v[24:27], v4 offset:59392
ds_read_b128 v[28:31], v4 offset:60416
s_waitcnt vmcnt(8) lgkmcnt(4)
v_mfma_f32_16x16x32_bf16 v[100:103], v[60:63], v[32:35], v[100:103]
v_mfma_f32_16x16x32_bf16 v[104:107], v[60:63], v[36:39], v[104:107]
v_mfma_f32_16x16x32_bf16 v[108:111], v[60:63], v[40:43], v[108:111]
v_mfma_f32_16x16x32_bf16 v[112:115], v[60:63], v[44:47], v[112:115]
v_mfma_f32_16x16x32_bf16 v[116:119], v[64:67], v[32:35], v[116:119]
v_mfma_f32_16x16x32_bf16 v[120:123], v[64:67], v[36:39], v[120:123]
v_mfma_f32_16x16x32_bf16 v[124:127], v[64:67], v[40:43], v[124:127]
v_mfma_f32_16x16x32_bf16 v[128:131], v[64:67], v[44:47], v[128:131]
ds_read_b128 v[32:35], v4 offset:61440
ds_read_b128 v[36:39], v4 offset:62464
ds_read_b128 v[40:43], v4 offset:63488
ds_read_b128 v[44:47], v4 offset:64512
s_waitcnt vmcnt(6) lgkmcnt(4)
v_mfma_f32_16x16x32_bf16 v[100:103], v[68:71], v[16:19], v[100:103]
v_mfma_f32_16x16x32_bf16 v[104:107], v[68:71], v[20:23], v[104:107]
v_mfma_f32_16x16x32_bf16 v[108:111], v[68:71], v[24:27], v[108:111]
v_mfma_f32_16x16x32_bf16 v[112:115], v[68:71], v[28:31], v[112:115]
v_mfma_f32_16x16x32_bf16 v[116:119], v[72:75], v[16:19], v[116:119]
v_mfma_f32_16x16x32_bf16 v[120:123], v[72:75], v[20:23], v[120:123]
v_mfma_f32_16x16x32_bf16 v[124:127], v[72:75], v[24:27], v[124:127]
v_mfma_f32_16x16x32_bf16 v[128:131], v[72:75], v[28:31], v[128:131]
ds_read_b128 v[16:19], v10 offset:0
ds_read_b128 v[20:23], v10 offset:1024
ds_read_b128 v[24:27], v10 offset:2048
ds_read_b128 v[28:31], v10 offset:3072
s_waitcnt vmcnt(4) lgkmcnt(4)
v_mfma_f32_16x16x32_bf16 v[100:103], v[76:79], v[32:35], v[100:103]
v_mfma_f32_16x16x32_bf16 v[104:107], v[76:79], v[36:39], v[104:107]
v_mfma_f32_16x16x32_bf16 v[108:111], v[76:79], v[40:43], v[108:111]
v_mfma_f32_16x16x32_bf16 v[112:115], v[76:79], v[44:47], v[112:115]
v_mfma_f32_16x16x32_bf16 v[116:119], v[80:83], v[32:35], v[116:119]
v_mfma_f32_16x16x32_bf16 v[120:123], v[80:83], v[36:39], v[120:123]
v_mfma_f32_16x16x32_bf16 v[124:127], v[80:83], v[40:43], v[124:127]
v_mfma_f32_16x16x32_bf16 v[128:131], v[80:83], v[44:47], v[128:131]
ds_read_b128 v[32:35], v10 offset:4096
ds_read_b128 v[36:39], v10 offset:5120
ds_read_b128 v[40:43], v10 offset:6144
ds_read_b128 v[44:47], v10 offset:7168
s_waitcnt vmcnt(2) lgkmcnt(4)
v_mfma_f32_16x16x32_bf16 v[100:103], v[84:87], v[16:19], v[100:103]
v_mfma_f32_16x16x32_bf16 v[104:107], v[84:87], v[20:23], v[104:107]
v_mfma_f32_16x16x32_bf16 v[108:111], v[84:87], v[24:27], v[108:111]
v_mfma_f32_16x16x32_bf16 v[112:115], v[84:87], v[28:31], v[112:115]
v_mfma_f32_16x16x32_bf16 v[116:119], v[88:91], v[16:19], v[116:119]
v_mfma_f32_16x16x32_bf16 v[120:123], v[88:91], v[20:23], v[120:123]
v_mfma_f32_16x16x32_bf16 v[124:127], v[88:91], v[24:27], v[124:127]
v_mfma_f32_16x16x32_bf16 v[128:131], v[88:91], v[28:31], v[128:131]
s_waitcnt vmcnt(0) lgkmcnt(0)
v_mfma_f32_16x16x32_bf16 v[100:103], v[92:95], v[32:35], v[100:103]
v_mfma_f32_16x16x32_bf16 v[104:107], v[92:95], v[36:39], v[104:107]
v_mfma_f32_16x16x32_bf16 v[108:111], v[92:95], v[40:43], v[108:111]
v_mfma_f32_16x16x32_bf16 v[112:115], v[92:95], v[44:47], v[112:115]
v_mfma_f32_16x16x32_bf16 v[116:119], v[96:99], v[32:35], v[116:119]
v_mfma_f32_16x16x32_bf16 v[120:123], v[96:99], v[36:39], v[120:123]
v_mfma_f32_16x16x32_bf16 v[124:127], v[96:99], v[40:43], v[124:127]
v_mfma_f32_16x16x32_bf16 v[128:131], v[96:99], v[44:47], v[128:131]
s_add_u32 s8, s20, 0x1400000
s_addc_u32 s9, s21, 0
s_mov_b32 s10, 0x200000
s_mov_b32 s11, 0x00020000
s_add_u32 s12, s20, 0x1600000
s_addc_u32 s13, s21, 0
s_mov_b32 s14, 0x80000
s_mov_b32 s15, 0x00020000
s_add_u32 s16, s20, 0x1700000
s_addc_u32 s17, s21, 0
s_mov_b32 s18, 0x4e0000
s_mov_b32 s19, 0x00020000
s_cmp_ge_u32 s25, 48
s_cbranch_scc1 k2_ext
s_lshl_b32 s28, s24, 11
s_cmp_ge_u32 s25, 16
s_cbranch_scc1 k2_kmain
s_mov_b32 s33, 0x3eae1a93
s_lshl_b32 s29, s25, 17
s_add_u32 s28, s28, s29
v_mul_f32 v100, s33, v100
v_mul_f32 v101, s33, v101
v_mul_f32 v102, s33, v102
v_mul_f32 v103, s33, v103
v_mul_f32 v104, s33, v104
v_mul_f32 v105, s33, v105
v_mul_f32 v106, s33, v106
v_mul_f32 v107, s33, v107
v_cvt_pk_bf16_f32 v132, v100, v101
v_cvt_pk_bf16_f32 v133, v102, v103
v_cvt_pk_bf16_f32 v134, v104, v105
v_cvt_pk_bf16_f32 v135, v106, v107
s_nop 0
v_permlane16_swap_b32 v132, v134
v_permlane16_swap_b32 v133, v135
s_add_u32 s29, s28, 0
buffer_store_dwordx4 v[132:135], v4, s[8:11], s29 offen
v_mul_f32 v108, s33, v108
v_mul_f32 v109, s33, v109
v_mul_f32 v110, s33, v110
v_mul_f32 v111, s33, v111
v_mul_f32 v112, s33, v112
v_mul_f32 v113, s33, v113
v_mul_f32 v114, s33, v114
v_mul_f32 v115, s33, v115
v_cvt_pk_bf16_f32 v136, v108, v109
v_cvt_pk_bf16_f32 v137, v110, v111
v_cvt_pk_bf16_f32 v138, v112, v113
v_cvt_pk_bf16_f32 v139, v114, v115
s_nop 0
v_permlane16_swap_b32 v136, v138
v_permlane16_swap_b32 v137, v139
s_add_u32 s29, s28, 1024
buffer_store_dwordx4 v[136:139], v4, s[8:11], s29 offen
v_mul_f32 v116, s33, v116
v_mul_f32 v117, s33, v117
v_mul_f32 v118, s33, v118
v_mul_f32 v119, s33, v119
v_mul_f32 v120, s33, v120
v_mul_f32 v121, s33, v121
v_mul_f32 v122, s33, v122
v_mul_f32 v123, s33, v123
v_cvt_pk_bf16_f32 v140, v116, v117
v_cvt_pk_bf16_f32 v141, v118, v119
v_cvt_pk_bf16_f32 v142, v120, v121
v_cvt_pk_bf16_f32 v143, v122, v123
s_nop 0
v_permlane16_swap_b32 v140, v142
v_permlane16_swap_b32 v141, v143
s_add_u32 s29, s28, 65536
buffer_store_dwordx4 v[140:143], v4, s[8:11], s29 offen
v_mul_f32 v124, s33, v124
v_mul_f32 v125, s33, v125
v_mul_f32 v126, s33, v126
v_mul_f32 v127, s33, v127
v_mul_f32 v128, s33, v128
v_mul_f32 v129, s33, v129
v_mul_f32 v130, s33, v130
v_mul_f32 v131, s33, v131
v_cvt_pk_bf16_f32 v144, v124, v125
v_cvt_pk_bf16_f32 v145, v126, v127
v_cvt_pk_bf16_f32 v146, v128, v129
v_cvt_pk_bf16_f32 v147, v130, v131
s_nop 0
v_permlane16_swap_b32 v144, v146
v_permlane16_swap_b32 v145, v147
s_add_u32 s29, s28, 66560
buffer_store_dwordx4 v[144:147], v4, s[8:11], s29 offen
s_endpgm
k2_kmain:
s_sub_u32 s29, s25, 16
s_mul_i32 s29, s29, 319488
s_add_u32 s28, s28, s29
v_cvt_pk_bf16_f32 v132, v100, v101
v_cvt_pk_bf16_f32 v133, v102, v103
v_cvt_pk_bf16_f32 v134, v104, v105
v_cvt_pk_bf16_f32 v135, v106, v107
s_nop 0
v_permlane16_swap_b32 v132, v134
v_permlane16_swap_b32 v133, v135
s_add_u32 s29, s28, 0
buffer_store_dwordx4 v[132:135], v4, s[16:19], s29 offen
v_cvt_pk_bf16_f32 v136, v108, v109
v_cvt_pk_bf16_f32 v137, v110, v111
v_cvt_pk_bf16_f32 v138, v112, v113
v_cvt_pk_bf16_f32 v139, v114, v115
s_nop 0
v_permlane16_swap_b32 v136, v138
v_permlane16_swap_b32 v137, v139
s_add_u32 s29, s28, 1024
buffer_store_dwordx4 v[136:139], v4, s[16:19], s29 offen
v_cvt_pk_bf16_f32 v140, v116, v117
v_cvt_pk_bf16_f32 v141, v118, v119
v_cvt_pk_bf16_f32 v142, v120, v121
v_cvt_pk_bf16_f32 v143, v122, v123
s_nop 0
v_permlane16_swap_b32 v140, v142
v_permlane16_swap_b32 v141, v143
s_add_u32 s29, s28, 159744
buffer_store_dwordx4 v[140:143], v4, s[16:19], s29 offen
v_cvt_pk_bf16_f32 v144, v124, v125
v_cvt_pk_bf16_f32 v145, v126, v127
v_cvt_pk_bf16_f32 v146, v128, v129
v_cvt_pk_bf16_f32 v147, v130, v131
s_nop 0
v_permlane16_swap_b32 v144, v146
v_permlane16_swap_b32 v145, v147
s_add_u32 s29, s28, 160768
buffer_store_dwordx4 v[144:147], v4, s[16:19], s29 offen
s_endpgm
k2_ext:
s_cmp_ge_u32 s25, 50
s_cbranch_scc1 k2_kext
s_mov_b32 s33, 0x3eae1a93
v_lshlrev_b32 v5, 15, v3
v_lshl_add_u32 v5, v2, 3, v5
s_sub_u32 s29, s25, 48
s_lshl_b32 s29, s29, 18
s_lshl_b32 s28, s24, 9
s_add_u32 s28, s28, s29
v_mov_b32 v133, 0
v_mov_b32 v135, 0
v_mul_f32 v100, s33, v100
v_mul_f32 v101, s33, v101
v_mul_f32 v102, s33, v102
v_mul_f32 v103, s33, v103
v_cvt_pk_bf16_f32 v132, v100, v101
v_cvt_pk_bf16_f32 v134, v102, v103
s_add_u32 s29, s28, 0
buffer_store_dwordx2 v[132:133], v5, s[12:15], s29 offen
s_add_u32 s29, s29, 16384
buffer_store_dwordx2 v[134:135], v5, s[12:15], s29 offen
v_mul_f32 v104, s33, v104
v_mul_f32 v105, s33, v105
v_mul_f32 v106, s33, v106
v_mul_f32 v107, s33, v107
v_cvt_pk_bf16_f32 v132, v104, v105
v_cvt_pk_bf16_f32 v134, v106, v107
s_add_u32 s29, s28, 128
buffer_store_dwordx2 v[132:133], v5, s[12:15], s29 offen
s_add_u32 s29, s29, 16384
buffer_store_dwordx2 v[134:135], v5, s[12:15], s29 offen
v_mul_f32 v108, s33, v108
v_mul_f32 v109, s33, v109
v_mul_f32 v110, s33, v110
v_mul_f32 v111, s33, v111
v_cvt_pk_bf16_f32 v132, v108, v109
v_cvt_pk_bf16_f32 v134, v110, v111
s_add_u32 s29, s28, 256
buffer_store_dwordx2 v[132:133], v5, s[12:15], s29 offen
s_add_u32 s29, s29, 16384
buffer_store_dwordx2 v[134:135], v5, s[12:15], s29 offen
v_mul_f32 v112, s33, v112
v_mul_f32 v113, s33, v113
v_mul_f32 v114, s33, v114
v_mul_f32 v115, s33, v115
v_cvt_pk_bf16_f32 v132, v112, v113
v_cvt_pk_bf16_f32 v134, v114, v115
s_add_u32 s29, s28, 384
buffer_store_dwordx2 v[132:133], v5, s[12:15], s29 offen
s_add_u32 s29, s29, 16384
buffer_store_dwordx2 v[134:135], v5, s[12:15], s29 offen
v_mul_f32 v116, s33, v116
v_mul_f32 v117, s33, v117
v_mul_f32 v118, s33, v118
v_mul_f32 v119, s33, v119
v_cvt_pk_bf16_f32 v132, v116, v117
v_cvt_pk_bf16_f32 v134, v118, v119
s_add_u32 s29, s28, 131072
buffer_store_dwordx2 v[132:133], v5, s[12:15], s29 offen
s_add_u32 s29, s29, 16384
buffer_store_dwordx2 v[134:135], v5, s[12:15], s29 offen
v_mul_f32 v120, s33, v120
v_mul_f32 v121, s33, v121
v_mul_f32 v122, s33, v122
v_mul_f32 v123, s33, v123
v_cvt_pk_bf16_f32 v132, v120, v121
v_cvt_pk_bf16_f32 v134, v122, v123
s_add_u32 s29, s28, 131200
buffer_store_dwordx2 v[132:133], v5, s[12:15], s29 offen
s_add_u32 s29, s29, 16384
buffer_store_dwordx2 v[134:135], v5, s[12:15], s29 offen
v_mul_f32 v124, s33, v124
v_mul_f32 v125, s33, v125
v_mul_f32 v126, s33, v126
v_mul_f32 v127, s33, v127
v_cvt_pk_bf16_f32 v132, v124, v125
v_cvt_pk_bf16_f32 v134, v126, v127
s_add_u32 s29, s28, 131328
buffer_store_dwordx2 v[132:133], v5, s[12:15], s29 offen
s_add_u32 s29, s29, 16384
buffer_store_dwordx2 v[134:135], v5, s[12:15], s29 offen
v_mul_f32 v128, s33, v128
v_mul_f32 v129, s33, v129
v_mul_f32 v130, s33, v130
v_mul_f32 v131, s33, v131
v_cvt_pk_bf16_f32 v132, v128, v129
v_cvt_pk_bf16_f32 v134, v130, v131
s_add_u32 s29, s28, 131456
buffer_store_dwordx2 v[132:133], v5, s[12:15], s29 offen
s_add_u32 s29, s29, 16384
buffer_store_dwordx2 v[134:135], v5, s[12:15], s29 offen
s_endpgm
k2_kext:
v_mul_u32_u24 v5, 319488, v3
v_lshl_add_u32 v5, v2, 3, v5
s_sub_u32 s29, s25, 50
s_mul_i32 s29, s29, 2555904
s_lshl_b32 s28, s24, 9
s_add_u32 s28, s28, s29
v_mov_b32 v133, 0x3f80
v_mov_b32 v135, 0x3f80
v_cvt_pk_bf16_f32 v132, v100, v101
v_cvt_pk_bf16_f32 v134, v102, v103
s_add_u32 s29, s28, 65536
buffer_store_dwordx2 v[132:133], v5, s[16:19], s29 offen
s_add_u32 s29, s29, 159744
buffer_store_dwordx2 v[134:135], v5, s[16:19], s29 offen
v_cvt_pk_bf16_f32 v132, v104, v105
v_cvt_pk_bf16_f32 v134, v106, v107
s_add_u32 s29, s28, 65664
buffer_store_dwordx2 v[132:133], v5, s[16:19], s29 offen
s_add_u32 s29, s29, 159744
buffer_store_dwordx2 v[134:135], v5, s[16:19], s29 offen
v_cvt_pk_bf16_f32 v132, v108, v109
v_cvt_pk_bf16_f32 v134, v110, v111
s_add_u32 s29, s28, 65792
buffer_store_dwordx2 v[132:133], v5, s[16:19], s29 offen
s_add_u32 s29, s29, 159744
buffer_store_dwordx2 v[134:135], v5, s[16:19], s29 offen
v_cvt_pk_bf16_f32 v132, v112, v113
v_cvt_pk_bf16_f32 v134, v114, v115
s_add_u32 s29, s28, 65920
buffer_store_dwordx2 v[132:133], v5, s[16:19], s29 offen
s_add_u32 s29, s29, 159744
buffer_store_dwordx2 v[134:135], v5, s[16:19], s29 offen
v_cvt_pk_bf16_f32 v132, v116, v117
v_cvt_pk_bf16_f32 v134, v118, v119
s_add_u32 s29, s28, 1343488
buffer_store_dwordx2 v[132:133], v5, s[16:19], s29 offen
s_add_u32 s29, s29, 159744
buffer_store_dwordx2 v[134:135], v5, s[16:19], s29 offen
v_cvt_pk_bf16_f32 v132, v120, v121
v_cvt_pk_bf16_f32 v134, v122, v123
s_add_u32 s29, s28, 1343616
buffer_store_dwordx2 v[132:133], v5, s[16:19], s29 offen
s_add_u32 s29, s29, 159744
buffer_store_dwordx2 v[134:135], v5, s[16:19], s29 offen
v_cvt_pk_bf16_f32 v132, v124, v125
v_cvt_pk_bf16_f32 v134, v126, v127
s_add_u32 s29, s28, 1343744
buffer_store_dwordx2 v[132:133], v5, s[16:19], s29 offen
s_add_u32 s29, s29, 159744
buffer_store_dwordx2 v[134:135], v5, s[16:19], s29 offen
v_cvt_pk_bf16_f32 v132, v128, v129
v_cvt_pk_bf16_f32 v134, v130, v131
s_add_u32 s29, s28, 1343872
buffer_store_dwordx2 v[132:133], v5, s[16:19], s29 offen
s_add_u32 s29, s29, 159744
buffer_store_dwordx2 v[134:135], v5, s[16:19], s29 offen
s_endpgm
k2_gv:
s_mov_b32 s41, s40
v_add_u32 v10, 0x10000, v4
ds_read_b128 v[16:19], v4 offset:0
ds_read_b128 v[20:23], v4 offset:1024
ds_read_b128 v[24:27], v4 offset:2048
ds_read_b128 v[28:31], v4 offset:3072
ds_read_b128 v[32:35], v4 offset:4096
ds_read_b128 v[36:39], v4 offset:5120
ds_read_b128 v[40:43], v4 offset:6144
ds_read_b128 v[44:47], v4 offset:7168
s_waitcnt vmcnt(10) lgkmcnt(4)
v_mfma_f32_16x16x32_bf16 v[100:103], v[16:19], v[52:55], 0
v_mfma_f32_16x16x32_bf16 v[104:107], v[20:23], v[52:55], 0
v_mfma_f32_16x16x32_bf16 v[108:111], v[24:27], v[52:55], 0
v_mfma_f32_16x16x32_bf16 v[112:115], v[28:31], v[52:55], 0
buffer_load_dwordx4 v[52:55], v4, s[16:19], s41 offen offset:0 sc1
v_mfma_f32_16x16x32_bf16 v[116:119], v[16:19], v[56:59], 0
v_mfma_f32_16x16x32_bf16 v[120:123], v[20:23], v[56:59], 0
v_mfma_f32_16x16x32_bf16 v[124:127], v[24:27], v[56:59], 0
v_mfma_f32_16x16x32_bf16 v[128:131], v[28:31], v[56:59], 0
buffer_load_dwordx4 v[56:59], v4, s[16:19], s41 offen offset:1024 sc1
s_add_u32 s41, s41, 2048
ds_read_b128 v[16:19], v4 offset:8192
ds_read_b128 v[20:23], v4 offset:9216
ds_read_b128 v[24:27], v4 offset:10240
ds_read_b128 v[28:31], v4 offset:11264
s_waitcnt vmcnt(10) lgkmcnt(4)
v_mfma_f32_16x16x32_bf16 v[100:103], v[32:35], v[60:63], v[100:103]
v_mfma_f32_16x16x32_bf16 v[104:107], v[36:39], v[60:63], v[104:107]
v_mfma_f32_16x16x32_bf16 v[108:111], v[40:43], v[60:63], v[108:111]
v_mfma_f32_16x16x32_bf16 v[112:115], v[44:47], v[60:63], v[112:115]
buffer_load_dwordx4 v[60:63], v4, s[16:19], s41 offen offset:0 sc1
v_mfma_f32_16x16x32_bf16 v[116:119], v[32:35], v[64:67], v[116:119]
v_mfma_f32_16x16x32_bf16 v[120:123], v[36:39], v[64:67], v[120:123]
v_mfma_f32_16x16x32_bf16 v[124:127], v[40:43], v[64:67], v[124:127]
v_mfma_f32_16x16x32_bf16 v[128:131], v[44:47], v[64:67], v[128:131]
buffer_load_dwordx4 v[64:67], v4, s[16:19], s41 offen offset:1024 sc1
s_add_u32 s41, s41, 2048
ds_read_b128 v[32:35], v4 offset:12288
ds_read_b128 v[36:39], v4 offset:13312
ds_read_b128 v[40:43], v4 offset:14336
ds_read_b128 v[44:47], v4 offset:15360
s_waitcnt vmcnt(10) lgkmcnt(4)
v_mfma_f32_16x16x32_bf16 v[100:103], v[16:19], v[68:71], v[100:103]
v_mfma_f32_16x16x32_bf16 v[104:107], v[20:23], v[68:71], v[104:107]
v_mfma_f32_16x16x32_bf16 v[108:111], v[24:27], v[68:71], v[108:111]
v_mfma_f32_16x16x32_bf16 v[112:115], v[28:31], v[68:71], v[112:115]
buffer_load_dwordx4 v[68:71], v4, s[16:19], s41 offen offset:0 sc1
v_mfma_f32_16x16x32_bf16 v[116:119], v[16:19], v[72:75], v[116:119]
v_mfma_f32_16x16x32_bf16 v[120:123], v[20:23], v[72:75], v[120:123]
v_mfma_f32_16x16x32_bf16 v[124:127], v[24:27], v[72:75], v[124:127]
v_mfma_f32_16x16x32_bf16 v[128:131], v[28:31], v[72:75], v[128:131]
buffer_load_dwordx4 v[72:75], v4, s[16:19], s41 offen offset:1024 sc1
s_add_u32 s41, s41, 2048
ds_read_b128 v[16:19], v4 offset:16384
ds_read_b128 v[20:23], v4 offset:17408
ds_read_b128 v[24:27], v4 offset:18432
ds_read_b128 v[28:31], v4 offset:19456
s_waitcnt vmcnt(10) lgkmcnt(4)
v_mfma_f32_16x16x32_bf16 v[100:103], v[32:35], v[76:79], v[100:103]
v_mfma_f32_16x16x32_bf16 v[104:107], v[36:39], v[76:79], v[104:107]
v_mfma_f32_16x16x32_bf16 v[108:111], v[40:43], v[76:79], v[108:111]
v_mfma_f32_16x16x32_bf16 v[112:115], v[44:47], v[76:79], v[112:115]
buffer_load_dwordx4 v[76:79], v4, s[16:19], s41 offen offset:0 sc1
v_mfma_f32_16x16x32_bf16 v[116:119], v[32:35], v[80:83], v[116:119]
v_mfma_f32_16x16x32_bf16 v[120:123], v[36:39], v[80:83], v[120:123]
v_mfma_f32_16x16x32_bf16 v[124:127], v[40:43], v[80:83], v[124:127]
v_mfma_f32_16x16x32_bf16 v[128:131], v[44:47], v[80:83], v[128:131]
buffer_load_dwordx4 v[80:83], v4, s[16:19], s41 offen offset:1024 sc1
s_add_u32 s41, s41, 2048
ds_read_b128 v[32:35], v4 offset:20480
ds_read_b128 v[36:39], v4 offset:21504
ds_read_b128 v[40:43], v4 offset:22528
ds_read_b128 v[44:47], v4 offset:23552
s_waitcnt vmcnt(10) lgkmcnt(4)
v_mfma_f32_16x16x32_bf16 v[100:103], v[16:19], v[84:87], v[100:103]
v_mfma_f32_16x16x32_bf16 v[104:107], v[20:23], v[84:87], v[104:107]
v_mfma_f32_16x16x32_bf16 v[108:111], v[24:27], v[84:87], v[108:111]
v_mfma_f32_16x16x32_bf16 v[112:115], v[28:31], v[84:87], v[112:115]
buffer_load_dwordx4 v[84:87], v4, s[16:19], s41 offen offset:0 sc1
v_mfma_f32_16x16x32_bf16 v[116:119], v[16:19], v[88:91], v[116:119]
v_mfma_f32_16x16x32_bf16 v[120:123], v[20:23], v[88:91], v[120:123]
v_mfma_f32_16x16x32_bf16 v[124:127], v[24:27], v[88:91], v[124:127]
v_mfma_f32_16x16x32_bf16 v[128:131], v[28:31], v[88:91], v[128:131]
buffer_load_dwordx4 v[88:91], v4, s[16:19], s41 offen offset:1024 sc1
s_add_u32 s41, s41, 2048
ds_read_b128 v[16:19], v4 offset:24576
ds_read_b128 v[20:23], v4 offset:25600
ds_read_b128 v[24:27], v4 offset:26624
ds_read_b128 v[28:31], v4 offset:27648
s_waitcnt vmcnt(10) lgkmcnt(4)
v_mfma_f32_16x16x32_bf16 v[100:103], v[32:35], v[92:95], v[100:103]
v_mfma_f32_16x16x32_bf16 v[104:107], v[36:39], v[92:95], v[104:107]
v_mfma_f32_16x16x32_bf16 v[108:111], v[40:43], v[92:95], v[108:111]
v_mfma_f32_16x16x32_bf16 v[112:115], v[44:47], v[92:95], v[112:115]
buffer_load_dwordx4 v[92:95], v4, s[16:19], s41 offen offset:0 sc1
v_mfma_f32_16x16x32_bf16 v[116:119], v[32:35], v[96:99], v[116:119]
v_mfma_f32_16x16x32_bf16 v[120:123], v[36:39], v[96:99], v[120:123]
v_mfma_f32_16x16x32_bf16 v[124:127], v[40:43], v[96:99], v[124:127]
v_mfma_f32_16x16x32_bf16 v[128:131], v[44:47], v[96:99], v[128:131]
buffer_load_dwordx4 v[96:99], v4, s[16:19], s41 offen offset:1024 sc1
s_add_u32 s41, s41, 2048
ds_read_b128 v[32:35], v4 offset:28672
ds_read_b128 v[36:39], v4 offset:29696
ds_read_b128 v[40:43], v4 offset:30720
ds_read_b128 v[44:47], v4 offset:31744
s_waitcnt vmcnt(10) lgkmcnt(4)
v_mfma_f32_16x16x32_bf16 v[100:103], v[16:19], v[52:55], v[100:103]
v_mfma_f32_16x16x32_bf16 v[104:107], v[20:23], v[52:55], v[104:107]
v_mfma_f32_16x16x32_bf16 v[108:111], v[24:27], v[52:55], v[108:111]
v_mfma_f32_16x16x32_bf16 v[112:115], v[28:31], v[52:55], v[112:115]
buffer_load_dwordx4 v[52:55], v4, s[16:19], s41 offen offset:0 sc1
v_mfma_f32_16x16x32_bf16 v[116:119], v[16:19], v[56:59], v[116:119]
v_mfma_f32_16x16x32_bf16 v[120:123], v[20:23], v[56:59], v[120:123]
v_mfma_f32_16x16x32_bf16 v[124:127], v[24:27], v[56:59], v[124:127]
v_mfma_f32_16x16x32_bf16 v[128:131], v[28:31], v[56:59], v[128:131]
buffer_load_dwordx4 v[56:59], v4, s[16:19], s41 offen offset:1024 sc1
s_add_u32 s41, s41, 2048
ds_read_b128 v[16:19], v4 offset:32768
ds_read_b128 v[20:23], v4 offset:33792
ds_read_b128 v[24:27], v4 offset:34816
ds_read_b128 v[28:31], v4 offset:35840
s_waitcnt vmcnt(10) lgkmcnt(4)
v_mfma_f32_16x16x32_bf16 v[100:103], v[32:35], v[60:63], v[100:103]
v_mfma_f32_16x16x32_bf16 v[104:107], v[36:39], v[60:63], v[104:107]
v_mfma_f32_16x16x32_bf16 v[108:111], v[40:43], v[60:63], v[108:111]
v_mfma_f32_16x16x32_bf16 v[112:115], v[44:47], v[60:63], v[112:115]
buffer_load_dwordx4 v[60:63], v4, s[16:19], s41 offen offset:0 sc1
v_mfma_f32_16x16x32_bf16 v[116:119], v[32:35], v[64:67], v[116:119]
v_mfma_f32_16x16x32_bf16 v[120:123], v[36:39], v[64:67], v[120:123]
v_mfma_f32_16x16x32_bf16 v[124:127], v[40:43], v[64:67], v[124:127]
v_mfma_f32_16x16x32_bf16 v[128:131], v[44:47], v[64:67], v[128:131]
buffer_load_dwordx4 v[64:67], v4, s[16:19], s41 offen offset:1024 sc1
s_add_u32 s41, s41, 2048
ds_read_b128 v[32:35], v4 offset:36864
ds_read_b128 v[36:39], v4 offset:37888
ds_read_b128 v[40:43], v4 offset:38912
ds_read_b128 v[44:47], v4 offset:39936
s_waitcnt vmcnt(10) lgkmcnt(4)
v_mfma_f32_16x16x32_bf16 v[100:103], v[16:19], v[68:71], v[100:103]
v_mfma_f32_16x16x32_bf16 v[104:107], v[20:23], v[68:71], v[104:107]
v_mfma_f32_16x16x32_bf16 v[108:111], v[24:27], v[68:71], v[108:111]
v_mfma_f32_16x16x32_bf16 v[112:115], v[28:31], v[68:71], v[112:115]
buffer_load_dwordx4 v[68:71], v4, s[16:19], s41 offen offset:0 sc1
v_mfma_f32_16x16x32_bf16 v[116:119], v[16:19], v[72:75], v[116:119]
v_mfma_f32_16x16x32_bf16 v[120:123], v[20:23], v[72:75], v[120:123]
v_mfma_f32_16x16x32_bf16 v[124:127], v[24:27], v[72:75], v[124:127]
v_mfma_f32_16x16x32_bf16 v[128:131], v[28:31], v[72:75], v[128:131]
buffer_load_dwordx4 v[72:75], v4, s[16:19], s41 offen offset:1024 sc1
s_add_u32 s41, s41, 2048
ds_read_b128 v[16:19], v4 offset:40960
ds_read_b128 v[20:23], v4 offset:41984
ds_read_b128 v[24:27], v4 offset:43008
ds_read_b128 v[28:31], v4 offset:44032
s_waitcnt vmcnt(10) lgkmcnt(4)
v_mfma_f32_16x16x32_bf16 v[100:103], v[32:35], v[76:79], v[100:103]
v_mfma_f32_16x16x32_bf16 v[104:107], v[36:39], v[76:79], v[104:107]
v_mfma_f32_16x16x32_bf16 v[108:111], v[40:43], v[76:79], v[108:111]
v_mfma_f32_16x16x32_bf16 v[112:115], v[44:47], v[76:79], v[112:115]
buffer_load_dwordx4 v[76:79], v4, s[16:19], s41 offen offset:0 sc1
v_mfma_f32_16x16x32_bf16 v[116:119], v[32:35], v[80:83], v[116:119]
v_mfma_f32_16x16x32_bf16 v[120:123], v[36:39], v[80:83], v[120:123]
v_mfma_f32_16x16x32_bf16 v[124:127], v[40:43], v[80:83], v[124:127]
v_mfma_f32_16x16x32_bf16 v[128:131], v[44:47], v[80:83], v[128:131]
buffer_load_dwordx4 v[80:83], v4, s[16:19], s41 offen offset:1024 sc1
s_add_u32 s41, s41, 2048
ds_read_b128 v[32:35], v4 offset:45056
ds_read_b128 v[36:39], v4 offset:46080
ds_read_b128 v[40:43], v4 offset:47104
ds_read_b128 v[44:47], v4 offset:48128
s_waitcnt vmcnt(10) lgkmcnt(4)
v_mfma_f32_16x16x32_bf16 v[100:103], v[16:19], v[84:87], v[100:103]
v_mfma_f32_16x16x32_bf16 v[104:107], v[20:23], v[84:87], v[104:107]
v_mfma_f32_16x16x32_bf16 v[108:111], v[24:27], v[84:87], v[108:111]
v_mfma_f32_16x16x32_bf16 v[112:115], v[28:31], v[84:87], v[112:115]
buffer_load_dwordx4 v[84:87], v4, s[16:19], s41 offen offset:0 sc1
v_mfma_f32_16x16x32_bf16 v[116:119], v[16:19], v[88:91], v[116:119]
v_mfma_f32_16x16x32_bf16 v[120:123], v[20:23], v[88:91], v[120:123]
v_mfma_f32_16x16x32_bf16 v[124:127], v[24:27], v[88:91], v[124:127]
v_mfma_f32_16x16x32_bf16 v[128:131], v[28:31], v[88:91], v[128:131]
buffer_load_dwordx4 v[88:91], v4, s[16:19], s41 offen offset:1024 sc1
s_add_u32 s41, s41, 2048
ds_read_b128 v[16:19], v4 offset:49152
ds_read_b128 v[20:23], v4 offset:50176
ds_read_b128 v[24:27], v4 offset:51200
ds_read_b128 v[28:31], v4 offset:52224
s_waitcnt vmcnt(10) lgkmcnt(4)
v_mfma_f32_16x16x32_bf16 v[100:103], v[32:35], v[92:95], v[100:103]
v_mfma_f32_16x16x32_bf16 v[104:107], v[36:39], v[92:95], v[104:107]
v_mfma_f32_16x16x32_bf16 v[108:111], v[40:43], v[92:95], v[108:111]
v_mfma_f32_16x16x32_bf16 v[112:115], v[44:47], v[92:95], v[112:115]
buffer_load_dwordx4 v[92:95], v4, s[16:19], s41 offen offset:0 sc1
v_mfma_f32_16x16x32_bf16 v[116:119], v[32:35], v[96:99], v[116:119]
v_mfma_f32_16x16x32_bf16 v[120:123], v[36:39], v[96:99], v[120:123]
v_mfma_f32_16x16x32_bf16 v[124:127], v[40:43], v[96:99], v[124:127]
v_mfma_f32_16x16x32_bf16 v[128:131], v[44:47], v[96:99], v[128:131]
buffer_load_dwordx4 v[96:99], v4, s[16:19], s41 offen offset:1024 sc1
s_add_u32 s41, s41, 2048
ds_read_b128 v[32:35], v4 offset:53248
ds_read_b128 v[36:39], v4 offset:54272
ds_read_b128 v[40:43], v4 offset:55296
ds_read_b128 v[44:47], v4 offset:56320
s_waitcnt vmcnt(10) lgkmcnt(4)
v_mfma_f32_16x16x32_bf16 v[100:103], v[16:19], v[52:55], v[100:103]
v_mfma_f32_16x16x32_bf16 v[104:107], v[20:23], v[52:55], v[104:107]
v_mfma_f32_16x16x32_bf16 v[108:111], v[24:27], v[52:55], v[108:111]
v_mfma_f32_16x16x32_bf16 v[112:115], v[28:31], v[52:55], v[112:115]
v_mfma_f32_16x16x32_bf16 v[116:119], v[16:19], v[56:59], v[116:119]
v_mfma_f32_16x16x32_bf16 v[120:123], v[20:23], v[56:59], v[120:123]
v_mfma_f32_16x16x32_bf16 v[124:127], v[24:27], v[56:59], v[124:127]
v_mfma_f32_16x16x32_bf16 v[128:131], v[28:31], v[56:59], v[128:131]
ds_read_b128 v[16:19], v4 offset:57344
ds_read_b128 v[20:23], v4 offset:58368
ds_read_b128 v[24:27], v4 offset:59392
ds_read_b128 v[28:31], v4 offset:60416
s_waitcnt vmcnt(8) lgkmcnt(4)
v_mfma_f32_16x16x32_bf16 v[100:103], v[32:35], v[60:63], v[100:103]
v_mfma_f32_16x16x32_bf16 v[104:107], v[36:39], v[60:63], v[104:107]
v_mfma_f32_16x16x32_bf16 v[108:111], v[40:43], v[60:63], v[108:111]
v_mfma_f32_16x16x32_bf16 v[112:115], v[44:47], v[60:63], v[112:115]
v_mfma_f32_16x16x32_bf16 v[116:119], v[32:35], v[64:67], v[116:119]
v_mfma_f32_16x16x32_bf16 v[120:123], v[36:39], v[64:67], v[120:123]
v_mfma_f32_16x16x32_bf16 v[124:127], v[40:43], v[64:67], v[124:127]
v_mfma_f32_16x16x32_bf16 v[128:131], v[44:47], v[64:67], v[128:131]
ds_read_b128 v[32:35], v4 offset:61440
ds_read_b128 v[36:39], v4 offset:62464
ds_read_b128 v[40:43], v4 offset:63488
ds_read_b128 v[44:47], v4 offset:64512
s_waitcnt vmcnt(6) lgkmcnt(4)
v_mfma_f32_16x16x32_bf16 v[100:103], v[16:19], v[68:71], v[100:103]
v_mfma_f32_16x16x32_bf16 v[104:107], v[20:23], v[68:71], v[104:107]
v_mfma_f32_16x16x32_bf16 v[108:111], v[24:27], v[68:71], v[108:111]
v_mfma_f32_16x16x32_bf16 v[112:115], v[28:31], v[68:71], v[112:115]
v_mfma_f32_16x16x32_bf16 v[116:119], v[16:19], v[72:75], v[116:119]
v_mfma_f32_16x16x32_bf16 v[120:123], v[20:23], v[72:75], v[120:123]
v_mfma_f32_16x16x32_bf16 v[124:127], v[24:27], v[72:75], v[124:127]
v_mfma_f32_16x16x32_bf16 v[128:131], v[28:31], v[72:75], v[128:131]
ds_read_b128 v[16:19], v10 offset:0
ds_read_b128 v[20:23], v10 offset:1024
ds_read_b128 v[24:27], v10 offset:2048
ds_read_b128 v[28:31], v10 offset:3072
s_waitcnt vmcnt(4) lgkmcnt(4)
v_mfma_f32_16x16x32_bf16 v[100:103], v[32:35], v[76:79], v[100:103]
v_mfma_f32_16x16x32_bf16 v[104:107], v[36:39], v[76:79], v[104:107]
v_mfma_f32_16x16x32_bf16 v[108:111], v[40:43], v[76:79], v[108:111]
v_mfma_f32_16x16x32_bf16 v[112:115], v[44:47], v[76:79], v[112:115]
v_mfma_f32_16x16x32_bf16 v[116:119], v[32:35], v[80:83], v[116:119]
v_mfma_f32_16x16x32_bf16 v[120:123], v[36:39], v[80:83], v[120:123]
v_mfma_f32_16x16x32_bf16 v[124:127], v[40:43], v[80:83], v[124:127]
v_mfma_f32_16x16x32_bf16 v[128:131], v[44:47], v[80:83], v[128:131]
ds_read_b128 v[32:35], v10 offset:4096
ds_read_b128 v[36:39], v10 offset:5120
ds_read_b128 v[40:43], v10 offset:6144
ds_read_b128 v[44:47], v10 offset:7168
s_waitcnt vmcnt(2) lgkmcnt(4)
v_mfma_f32_16x16x32_bf16 v[100:103], v[16:19], v[84:87], v[100:103]
v_mfma_f32_16x16x32_bf16 v[104:107], v[20:23], v[84:87], v[104:107]
v_mfma_f32_16x16x32_bf16 v[108:111], v[24:27], v[84:87], v[108:111]
v_mfma_f32_16x16x32_bf16 v[112:115], v[28:31], v[84:87], v[112:115]
v_mfma_f32_16x16x32_bf16 v[116:119], v[16:19], v[88:91], v[116:119]
v_mfma_f32_16x16x32_bf16 v[120:123], v[20:23], v[88:91], v[120:123]
v_mfma_f32_16x16x32_bf16 v[124:127], v[24:27], v[88:91], v[124:127]
v_mfma_f32_16x16x32_bf16 v[128:131], v[28:31], v[88:91], v[128:131]
s_waitcnt vmcnt(0) lgkmcnt(0)
v_mfma_f32_16x16x32_bf16 v[100:103], v[32:35], v[92:95], v[100:103]
v_mfma_f32_16x16x32_bf16 v[104:107], v[36:39], v[92:95], v[104:107]
v_mfma_f32_16x16x32_bf16 v[108:111], v[40:43], v[92:95], v[108:111]
v_mfma_f32_16x16x32_bf16 v[112:115], v[44:47], v[92:95], v[112:115]
v_mfma_f32_16x16x32_bf16 v[116:119], v[32:35], v[96:99], v[116:119]
v_mfma_f32_16x16x32_bf16 v[120:123], v[36:39], v[96:99], v[120:123]
v_mfma_f32_16x16x32_bf16 v[124:127], v[40:43], v[96:99], v[124:127]
v_mfma_f32_16x16x32_bf16 v[128:131], v[44:47], v[96:99], v[128:131]
s_add_u32 s16, s20, 0x1700000
s_addc_u32 s17, s21, 0
s_mov_b32 s18, 0x4e0000
s_mov_b32 s19, 0x00020000
v_and_b32 v6, 1, v3
v_mul_u32_u24 v5, 304, v6
v_lshrrev_b32 v6, 1, v3
v_mul_u32_u24 v6, 608, v6
v_add_u32 v5, v5, v6
s_mul_i32 s28, s24, 2432
s_cmp_ge_u32 s25, 52
s_cbranch_scc1 k2_vext
v_lshl_add_u32 v5, v2, 4, v5
s_sub_u32 s29, s25, 32
s_mul_i32 s29, s29, 319488
s_add_u32 s28, s28, s29
s_mov_b32 s31, 159744
s_branch k2_vstore
k2_vext:
v_lshrrev_b32 v6, 1, v2
v_mul_u32_u24 v6, 159744, v6
v_add_u32 v5, v5, v6
v_and_b32 v6, 1, v2
v_lshl_add_u32 v5, v6, 4, v5
v_add_u32 v5, 256, v5
s_sub_u32 s29, s25, 52
s_mul_i32 s29, s29, 2555904
s_add_u32 s28, s28, s29
s_mov_b32 s31, 1277952
k2_vstore:
v_cvt_pk_bf16_f32 v132, v100, v101
v_cvt_pk_bf16_f32 v133, v102, v103
v_cvt_pk_bf16_f32 v134, v104, v105
v_cvt_pk_bf16_f32 v135, v106, v107
s_nop 0
v_permlane32_swap_b32 v132, v134
v_permlane32_swap_b32 v133, v135
s_add_u32 s29, s28, 81920
buffer_store_dwordx4 v[132:135], v5, s[16:19], s29 offen
v_cvt_pk_bf16_f32 v136, v108, v109
v_cvt_pk_bf16_f32 v137, v110, v111
v_cvt_pk_bf16_f32 v138, v112, v113
v_cvt_pk_bf16_f32 v139, v114, v115
s_nop 0
v_permlane32_swap_b32 v136, v138
v_permlane32_swap_b32 v137, v139
s_add_u32 s29, s28, 83136
buffer_store_dwordx4 v[136:139], v5, s[16:19], s29 offen
s_add_u32 s28, s28, s31
v_cvt_pk_bf16_f32 v140, v116, v117
v_cvt_pk_bf16_f32 v141, v118, v119
v_cvt_pk_bf16_f32 v142, v120, v121
v_cvt_pk_bf16_f32 v143, v122, v123
s_nop 0
v_permlane32_swap_b32 v140, v142
v_permlane32_swap_b32 v141, v143
s_add_u32 s29, s28, 81920
buffer_store_dwordx4 v[140:143], v5, s[16:19], s29 offen
v_cvt_pk_bf16_f32 v144, v124, v125
v_cvt_pk_bf16_f32 v145, v126, v127
v_cvt_pk_bf16_f32 v146, v128, v129
v_cvt_pk_bf16_f32 v147, v130, v131
s_nop 0
v_permlane32_swap_b32 v144, v146
v_permlane32_swap_b32 v145, v147
s_add_u32 s29, s28, 83136
buffer_store_dwordx4 v[144:147], v5, s[16:19], s29 offen
s_endpgm
k2_exit:
s_endpgm
.section .rodata,"a"
.p2align 6
.amdhsa_kernel kf_front_kernel
  .amdhsa_next_free_vgpr 152
  .amdhsa_next_free_sgpr 64
  .amdhsa_accum_offset 152
  .amdhsa_group_segment_fixed_size 0
  .amdhsa_kernarg_size 96
  .amdhsa_user_sgpr_count 2
  .amdhsa_user_sgpr_kernarg_segment_ptr 1
  .amdhsa_system_sgpr_workgroup_id_x 1
  .amdhsa_float_denorm_mode_32 3
.end_amdhsa_kernel

.text
.globl k3_attn_kernel
.p2align 8
.type k3_attn_kernel,@function
k3_attn_kernel:
s_cmp_ge_u32 s2, 256
s_cbranch_scc1 k3_exit
s_load_dwordx2 s[20:21], s[0:1], 88
v_lshrrev_b32 v1, 6, v0
s_nop 0
v_readfirstlane_b32 s22, v1
s_nop 0
s_cmp_ge_u32 s22, 8
s_cbranch_scc1 k3_helper
v_and_b32 v1, 63, v0
v_lshlrev_b32 v2, 4, v1
v_and_b32 v3, 31, v1
v_lshrrev_b32 v4, 5, v1
s_and_b32 s23, s2, 31
s_lshr_b32 s24, s2, 5
s_waitcnt lgkmcnt(0)
s_add_u32 s8, s20, 0x1700000
s_addc_u32 s9, s21, 0
s_mov_b32 s10, 0x4e0000
s_mov_b32 s11, 0x00020000
s_add_u32 s12, s20, 0x1400000
s_addc_u32 s13, s21, 0
s_mov_b32 s14, 0x200000
s_mov_b32 s15, 0x00020000
s_add_u32 s16, s20, 0x1600000
s_addc_u32 s17, s21, 0
s_mov_b32 s18, 0x80000
s_mov_b32 s19, 0x00020000
s_lshl_b32 s25, s24, 3
s_add_u32 s25, s25, s22
s_lshl_b32 s26, s23, 16
s_lshl_b32 s27, s25, 10
s_add_u32 s26, s26, s27
buffer_load_dwordx4 v[8:11], v2, s[12:15], s26 offen
s_lshl_b32 s26, s23, 14
s_lshl_b32 s27, s25, 8
s_add_u32 s26, s26, s27
v_lshlrev_b32 v5, 3, v3
buffer_load_dwordx2 v[12:13], v5, s[16:19], s26 offen
s_mul_i32 s28, s23, 159744
s_add_u32 s29, s22, 0
s_lshl_b32 s29, s29, 10
s_add_u32 s29, s29, 0
s_mov_b32 m0, s29
s_add_u32 s30, s28, s29
buffer_load_dwordx4 v2, s[8:11], s30 offen lds
s_add_u32 s29, s22, 8
s_lshl_b32 s29, s29, 10
s_add_u32 s29, s29, 0
s_mov_b32 m0, s29
s_add_u32 s30, s28, s29
buffer_load_dwordx4 v2, s[8:11], s30 offen lds
s_add_u32 s29, s22, 0
s_min_u32 s29, s29, 3
s_lshl_b32 s29, s29, 10
s_add_u32 s29, s29, 65536
s_mov_b32 m0, s29
s_add_u32 s30, s28, s29
buffer_load_dwordx4 v2, s[8:11], s30 offen lds
s_add_u32 s29, s22, 0
s_lshl_b32 s29, s29, 10
s_add_u32 s29, s29, 81920
s_mov_b32 m0, s29
s_add_u32 s30, s28, s29
buffer_load_dwordx4 v2, s[8:11], s30 offen lds
s_add_u32 s29, s22, 8
s_lshl_b32 s29, s29, 10
s_add_u32 s29, s29, 81920
s_mov_b32 m0, s29
s_add_u32 s30, s28, s29
buffer_load_dwordx4 v2, s[8:11], s30 offen lds
s_add_u32 s29, s22, 16
s_min_u32 s29, s29, 18
s_lshl_b32 s29, s29, 10
s_add_u32 s29, s29, 81920
s_mov_b32 m0, s29
s_add_u32 s30, s28, s29
buffer_load_dwordx4 v2, s[8:11], s30 offen lds
v_mov_b32 v6, 159744
v_mov_b32 v7, 0
ds_write_b32 v6, v7
ds_write_b32 v6, v7 offset:4
ds_write_b32 v6, v7 offset:8
ds_write_b32 v6, v7 offset:12
v_mov_b32 v100, v2
v_lshlrev_b32 v101, 3, v3
v_add_u32 v101, 65536, v101
v_min_u32 v5, 18, v3
v_cmp_lt_u32 vcc, 19, v3
s_nop 1
v_cndmask_b32 v5, v5, 0, vcc
v_mov_b32 v6, 4
v_cmp_lt_u32 vcc, 27, v3
s_nop 1
v_cndmask_b32 v5, v5, v6, vcc
v_lshlrev_b32 v5, 4, v5
v_mul_u32_u24 v6, 304, v4
v_add_u32 v5, v5, v6
v_add_u32 v102, 81920, v5
s_waitcnt vmcnt(6)
v_cmp_eq_u32 vcc, 0, v4
s_nop 1
v_cndmask_b32 v12, 0, v12, vcc
v_mov_b32 v13, 0
s_waitcnt vmcnt(0) lgkmcnt(0)
s_barrier
s_mov_b32 s34, 0
ds_read_b128 v[72:75], v100 offset:0
ds_read_b64 v[80:81], v101 offset:0
s_waitcnt lgkmcnt(0)
v_mfma_f32_32x32x16_bf16 v[16:31], v[72:75], v[8:11], 0
v_mfma_f32_32x32x8bf16_1k v[16:31], v[80:81], v[12:13], v[16:31]
s_nop 11
v_max3_f32 v104, v16, v17, v18
v_max_f32 v104, v104, v19
v_max3_f32 v104, v20, v21, v104
v_max3_f32 v104, v22, v23, v104
v_max3_f32 v104, v24, v25, v104
v_max3_f32 v104, v26, v27, v104
v_max3_f32 v104, v28, v29, v104
v_max3_f32 v104, v30, v31, v104
v_mov_b32 v105, v104
s_nop 1
v_permlane32_swap_b32 v104, v105
v_max_f32 v104, v104, v105
v_sub_f32 v104, 0, v104
v_cvt_pk_bf16_f32 v104, v104, 0
v_and_b32 v104, 0xffff, v104
v_cmp_eq_u32 vcc, 0, v4
s_nop 1
v_cndmask_b32 v13, 0, v104, vcc
k3_pass:
v_mov_b32 v100, v2
v_lshlrev_b32 v101, 3, v3
v_add_u32 v101, 65536, v101
v_add_u32 v102, 81920, v5
v_mov_b32 v56, 0
v_mov_b32 v57, 0
v_mov_b32 v58, 0
v_mov_b32 v59, 0
v_mov_b32 v60, 0
v_mov_b32 v61, 0
v_mov_b32 v62, 0
v_mov_b32 v63, 0
v_mov_b32 v64, 0
v_mov_b32 v65, 0
v_mov_b32 v66, 0
v_mov_b32 v67, 0
v_mov_b32 v68, 0
v_mov_b32 v69, 0
v_mov_b32 v70, 0
v_mov_b32 v71, 0
v_mov_b32 v96, 0
v_mov_b32 v97, 0
v_mov_b32 v98, 0
v_mov_b32 v99, 0
v_mov_b32 v52, 0
v_mov_b32 v53, 0
v_mov_b32 v54, 0
v_mov_b32 v46, 0
v_mov_b32 v47, 0
ds_read_b128 v[72:75], v100 offset:0
ds_read_b64 v[80:81], v101 offset:0
ds_read_b128 v[76:79], v100 offset:1024
ds_read_b64 v[82:83], v101 offset:256
ds_read_b128 v[84:87], v102 offset:0
ds_read_b128 v[88:91], v102 offset:608
s_waitcnt lgkmcnt(4)
v_mfma_f32_32x32x16_bf16 v[16:31], v[72:75], v[8:11], 0
v_mfma_f32_32x32x8bf16_1k v[16:31], v[80:81], v[12:13], v[16:31]
ds_read_b128 v[72:75], v100 offset:2048
ds_read_b64 v[80:81], v101 offset:512
s_mov_b32 s33, 3
k3_loop1:
s_waitcnt lgkmcnt(2)
s_nop 7
v_exp_f32 v16, v16
v_exp_f32 v17, v17
v_cvt_pk_bf16_f32 v55, v46, v47
v_exp_f32 v18, v18
v_exp_f32 v19, v19
v_mfma_f32_32x32x16_bf16 v[56:71], v[96:99], v[52:55], v[56:71]
ds_read_b128 v[92:95], v102 offset:1216
ds_read_b128 v[96:99], v102 offset:1824
v_cvt_pk_bf16_f32 v48, v16, v17
v_exp_f32 v20, v20
v_exp_f32 v21, v21
v_cvt_pk_bf16_f32 v49, v18, v19
v_exp_f32 v22, v22
v_mfma_f32_32x32x16_bf16 v[32:47], v[76:79], v[8:11], 0
v_exp_f32 v23, v23
v_cvt_pk_bf16_f32 v50, v20, v21
v_exp_f32 v24, v24
v_exp_f32 v25, v25
v_cvt_pk_bf16_f32 v51, v22, v23
v_exp_f32 v26, v26
v_mfma_f32_32x32x8bf16_1k v[32:47], v[82:83], v[12:13], v[32:47]
v_exp_f32 v27, v27
v_cvt_pk_bf16_f32 v52, v24, v25
v_exp_f32 v28, v28
v_exp_f32 v29, v29
v_mfma_f32_32x32x16_bf16 v[56:71], v[84:87], v[48:51], v[56:71]
v_cvt_pk_bf16_f32 v53, v26, v27
v_exp_f32 v30, v30
v_exp_f32 v31, v31
v_cvt_pk_bf16_f32 v54, v28, v29
ds_read_b128 v[76:79], v100 offset:3072
ds_read_b64 v[82:83], v101 offset:768
s_waitcnt lgkmcnt(2)
v_exp_f32 v32, v32
v_exp_f32 v33, v33
v_cvt_pk_bf16_f32 v55, v30, v31
v_exp_f32 v34, v34
v_exp_f32 v35, v35
v_mfma_f32_32x32x16_bf16 v[56:71], v[88:91], v[52:55], v[56:71]
ds_read_b128 v[84:87], v102 offset:2432
ds_read_b128 v[88:91], v102 offset:3040
v_cvt_pk_bf16_f32 v48, v32, v33
v_exp_f32 v36, v36
v_exp_f32 v37, v37
v_cvt_pk_bf16_f32 v49, v34, v35
v_exp_f32 v38, v38
v_mfma_f32_32x32x16_bf16 v[16:31], v[72:75], v[8:11], 0
v_exp_f32 v39, v39
v_cvt_pk_bf16_f32 v50, v36, v37
v_exp_f32 v40, v40
v_exp_f32 v41, v41
v_cvt_pk_bf16_f32 v51, v38, v39
v_exp_f32 v42, v42
v_mfma_f32_32x32x8bf16_1k v[16:31], v[80:81], v[12:13], v[16:31]
v_exp_f32 v43, v43
v_cvt_pk_bf16_f32 v52, v40, v41
v_exp_f32 v44, v44
v_exp_f32 v45, v45
v_mfma_f32_32x32x16_bf16 v[56:71], v[92:95], v[48:51], v[56:71]
v_cvt_pk_bf16_f32 v53, v42, v43
v_exp_f32 v46, v46
v_exp_f32 v47, v47
v_cvt_pk_bf16_f32 v54, v44, v45
ds_read_b128 v[72:75], v100 offset:4096
ds_read_b64 v[80:81], v101 offset:1024
s_waitcnt lgkmcnt(2)
v_exp_f32 v16, v16
v_exp_f32 v17, v17
v_cvt_pk_bf16_f32 v55, v46, v47
v_exp_f32 v18, v18
v_exp_f32 v19, v19
v_mfma_f32_32x32x16_bf16 v[56:71], v[96:99], v[52:55], v[56:71]
ds_read_b128 v[92:95], v102 offset:3648
ds_read_b128 v[96:99], v102 offset:4256
v_cvt_pk_bf16_f32 v48, v16, v17
v_exp_f32 v20, v20
v_exp_f32 v21, v21
v_cvt_pk_bf16_f32 v49, v18, v19
v_exp_f32 v22, v22
v_mfma_f32_32x32x16_bf16 v[32:47], v[76:79], v[8:11], 0
v_exp_f32 v23, v23
v_cvt_pk_bf16_f32 v50, v20, v21
v_exp_f32 v24, v24
v_exp_f32 v25, v25
v_cvt_pk_bf16_f32 v51, v22, v23
v_exp_f32 v26, v26
v_mfma_f32_32x32x8bf16_1k v[32:47], v[82:83], v[12:13], v[32:47]
v_exp_f32 v27, v27
v_cvt_pk_bf16_f32 v52, v24, v25
v_exp_f32 v28, v28
v_exp_f32 v29, v29
v_mfma_f32_32x32x16_bf16 v[56:71], v[84:87], v[48:51], v[56:71]
v_cvt_pk_bf16_f32 v53, v26, v27
v_exp_f32 v30, v30
v_exp_f32 v31, v31
v_cvt_pk_bf16_f32 v54, v28, v29
ds_read_b128 v[76:79], v100 offset:5120
ds_read_b64 v[82:83], v101 offset:1280
s_waitcnt lgkmcnt(2)
v_exp_f32 v32, v32
v_exp_f32 v33, v33
v_cvt_pk_bf16_f32 v55, v30, v31
v_exp_f32 v34, v34
v_exp_f32 v35, v35
v_mfma_f32_32x32x16_bf16 v[56:71], v[88:91], v[52:55], v[56:71]
ds_read_b128 v[84:87], v102 offset:4864
ds_read_b128 v[88:91], v102 offset:5472
v_cvt_pk_bf16_f32 v48, v32, v33
v_exp_f32 v36, v36
v_exp_f32 v37, v37
v_cvt_pk_bf16_f32 v49, v34, v35
v_exp_f32 v38, v38
v_mfma_f32_32x32x16_bf16 v[16:31], v[72:75], v[8:11], 0
v_exp_f32 v39, v39
v_cvt_pk_bf16_f32 v50, v36, v37
v_exp_f32 v40, v40
v_exp_f32 v41, v41
v_cvt_pk_bf16_f32 v51, v38, v39
v_exp_f32 v42, v42
v_mfma_f32_32x32x8bf16_1k v[16:31], v[80:81], v[12:13], v[16:31]
v_exp_f32 v43, v43
v_cvt_pk_bf16_f32 v52, v40, v41
v_exp_f32 v44, v44
v_exp_f32 v45, v45
v_mfma_f32_32x32x16_bf16 v[56:71], v[92:95], v[48:51], v[56:71]
v_cvt_pk_bf16_f32 v53, v42, v43
v_exp_f32 v46, v46
v_exp_f32 v47, v47
v_cvt_pk_bf16_f32 v54, v44, v45
ds_read_b128 v[72:75], v100 offset:6144
ds_read_b64 v[80:81], v101 offset:1536
v_add_u32 v100, 4096, v100
v_add_u32 v101, 1024, v101
v_add_u32 v102, 4864, v102
s_sub_u32 s33, s33, 1
s_cmp_lg_u32 s33, 0
s_cbranch_scc1 k3_loop1
s_cmp_lg_u32 s34, 0
s_cbranch_scc1 k3_nosync
v_mov_b32 v6, 159744
k3_poll:
ds_read_b32 v7, v6
s_waitcnt lgkmcnt(0)
v_readfirstlane_b32 s33, v7
s_nop 0
s_cmp_ge_u32 s33, 4
s_cbranch_scc0 k3_poll
k3_nosync:
s_mov_b32 s33, 12
k3_loop2:
s_waitcnt lgkmcnt(2)
v_exp_f32 v16, v16
v_exp_f32 v17, v17
v_cvt_pk_bf16_f32 v55, v46, v47
v_exp_f32 v18, v18
v_exp_f32 v19, v19
v_mfma_f32_32x32x16_bf16 v[56:71], v[96:99], v[52:55], v[56:71]
ds_read_b128 v[92:95], v102 offset:1216
ds_read_b128 v[96:99], v102 offset:1824
v_cvt_pk_bf16_f32 v48, v16, v17
v_exp_f32 v20, v20
v_exp_f32 v21, v21
v_cvt_pk_bf16_f32 v49, v18, v19
v_exp_f32 v22, v22
v_mfma_f32_32x32x16_bf16 v[32:47], v[76:79], v[8:11], 0
v_exp_f32 v23, v23
v_cvt_pk_bf16_f32 v50, v20, v21
v_exp_f32 v24, v24
v_exp_f32 v25, v25
v_cvt_pk_bf16_f32 v51, v22, v23
v_exp_f32 v26, v26
v_mfma_f32_32x32x8bf16_1k v[32:47], v[82:83], v[12:13], v[32:47]
v_exp_f32 v27, v27
v_cvt_pk_bf16_f32 v52, v24, v25
v_exp_f32 v28, v28
v_exp_f32 v29, v29
v_mfma_f32_32x32x16_bf16 v[56:71], v[84:87], v[48:51], v[56:71]
v_cvt_pk_bf16_f32 v53, v26, v27
v_exp_f32 v30, v30
v_exp_f32 v31, v31
v_cvt_pk_bf16_f32 v54, v28, v29
ds_read_b128 v[76:79], v100 offset:3072
ds_read_b64 v[82:83], v101 offset:768
s_waitcnt lgkmcnt(2)
v_exp_f32 v32, v32
v_exp_f32 v33, v33
v_cvt_pk_bf16_f32 v55, v30, v31
v_exp_f32 v34, v34
v_exp_f32 v35, v35
v_mfma_f32_32x32x16_bf16 v[56:71], v[88:91], v[52:55], v[56:71]
ds_read_b128 v[84:87], v102 offset:2432
ds_read_b128 v[88:91], v102 offset:3040
v_cvt_pk_bf16_f32 v48, v32, v33
v_exp_f32 v36, v36
v_exp_f32 v37, v37
v_cvt_pk_bf16_f32 v49, v34, v35
v_exp_f32 v38, v38
v_mfma_f32_32x32x16_bf16 v[16:31], v[72:75], v[8:11], 0
v_exp_f32 v39, v39
v_cvt_pk_bf16_f32 v50, v36, v37
v_exp_f32 v40, v40
v_exp_f32 v41, v41
v_cvt_pk_bf16_f32 v51, v38, v39
v_exp_f32 v42, v42
v_mfma_f32_32x32x8bf16_1k v[16:31], v[80:81], v[12:13], v[16:31]
v_exp_f32 v43, v43
v_cvt_pk_bf16_f32 v52, v40, v41
v_exp_f32 v44, v44
v_exp_f32 v45, v45
v_mfma_f32_32x32x16_bf16 v[56:71], v[92:95], v[48:51], v[56:71]
v_cvt_pk_bf16_f32 v53, v42, v43
v_exp_f32 v46, v46
v_exp_f32 v47, v47
v_cvt_pk_bf16_f32 v54, v44, v45
ds_read_b128 v[72:75], v100 offset:4096
ds_read_b64 v[80:81], v101 offset:1024
s_waitcnt lgkmcnt(2)
v_exp_f32 v16, v16
v_exp_f32 v17, v17
v_cvt_pk_bf16_f32 v55, v46, v47
v_exp_f32 v18, v18
v_exp_f32 v19, v19
v_mfma_f32_32x32x16_bf16 v[56:71], v[96:99], v[52:55], v[56:71]
ds_read_b128 v[92:95], v102 offset:3648
ds_read_b128 v[96:99], v102 offset:4256
v_cvt_pk_bf16_f32 v48, v16, v17
v_exp_f32 v20, v20
v_exp_f32 v21, v21
v_cvt_pk_bf16_f32 v49, v18, v19
v_exp_f32 v22, v22
v_mfma_f32_32x32x16_bf16 v[32:47], v[76:79], v[8:11], 0
v_exp_f32 v23, v23
v_cvt_pk_bf16_f32 v50, v20, v21
v_exp_f32 v24, v24
v_exp_f32 v25, v25
v_cvt_pk_bf16_f32 v51, v22, v23
v_exp_f32 v26, v26
v_mfma_f32_32x32x8bf16_1k v[32:47], v[82:83], v[12:13], v[32:47]
v_exp_f32 v27, v27
v_cvt_pk_bf16_f32 v52, v24, v25
v_exp_f32 v28, v28
v_exp_f32 v29, v29
v_mfma_f32_32x32x16_bf16 v[56:71], v[84:87], v[48:51], v[56:71]
v_cvt_pk_bf16_f32 v53, v26, v27
v_exp_f32 v30, v30
v_exp_f32 v31, v31
v_cvt_pk_bf16_f32 v54, v28, v29
ds_read_b128 v[76:79], v100 offset:5120
ds_read_b64 v[82:83], v101 offset:1280
s_waitcnt lgkmcnt(2)
v_exp_f32 v32, v32
v_exp_f32 v33, v33
v_cvt_pk_bf16_f32 v55, v30, v31
v_exp_f32 v34, v34
v_exp_f32 v35, v35
v_mfma_f32_32x32x16_bf16 v[56:71], v[88:91], v[52:55], v[56:71]
ds_read_b128 v[84:87], v102 offset:4864
ds_read_b128 v[88:91], v102 offset:5472
v_cvt_pk_bf16_f32 v48, v32, v33
v_exp_f32 v36, v36
v_exp_f32 v37, v37
v_cvt_pk_bf16_f32 v49, v34, v35
v_exp_f32 v38, v38
v_mfma_f32_32x32x16_bf16 v[16:31], v[72:75], v[8:11], 0
v_exp_f32 v39, v39
v_cvt_pk_bf16_f32 v50, v36, v37
v_exp_f32 v40, v40
v_exp_f32 v41, v41
v_cvt_pk_bf16_f32 v51, v38, v39
v_exp_f32 v42, v42
v_mfma_f32_32x32x8bf16_1k v[16:31], v[80:81], v[12:13], v[16:31]
v_exp_f32 v43, v43
v_cvt_pk_bf16_f32 v52, v40, v41
v_exp_f32 v44, v44
v_exp_f32 v45, v45
v_mfma_f32_32x32x16_bf16 v[56:71], v[92:95], v[48:51], v[56:71]
v_cvt_pk_bf16_f32 v53, v42, v43
v_exp_f32 v46, v46
v_exp_f32 v47, v47
v_cvt_pk_bf16_f32 v54, v44, v45
ds_read_b128 v[72:75], v100 offset:6144
ds_read_b64 v[80:81], v101 offset:1536
v_add_u32 v100, 4096, v100
v_add_u32 v101, 1024, v101
v_add_u32 v102, 4864, v102
s_sub_u32 s33, s33, 1
s_cmp_lg_u32 s33, 0
s_cbranch_scc1 k3_loop2
s_waitcnt lgkmcnt(2)
v_exp_f32 v16, v16
v_exp_f32 v17, v17
v_cvt_pk_bf16_f32 v55, v46, v47
v_exp_f32 v18, v18
v_exp_f32 v19, v19
v_mfma_f32_32x32x16_bf16 v[56:71], v[96:99], v[52:55], v[56:71]
ds_read_b128 v[92:95], v102 offset:1216
ds_read_b128 v[96:99], v102 offset:1824
v_cvt_pk_bf16_f32 v48, v16, v17
v_exp_f32 v20, v20
v_exp_f32 v21, v21
v_cvt_pk_bf16_f32 v49, v18, v19
v_exp_f32 v22, v22
v_mfma_f32_32x32x16_bf16 v[32:47], v[76:79], v[8:11], 0
v_exp_f32 v23, v23
v_cvt_pk_bf16_f32 v50, v20, v21
v_exp_f32 v24, v24
v_exp_f32 v25, v25
v_cvt_pk_bf16_f32 v51, v22, v23
v_exp_f32 v26, v26
v_mfma_f32_32x32x8bf16_1k v[32:47], v[82:83], v[12:13], v[32:47]
v_exp_f32 v27, v27
v_cvt_pk_bf16_f32 v52, v24, v25
v_exp_f32 v28, v28
v_exp_f32 v29, v29
v_mfma_f32_32x32x16_bf16 v[56:71], v[84:87], v[48:51], v[56:71]
v_cvt_pk_bf16_f32 v53, v26, v27
v_exp_f32 v30, v30
v_exp_f32 v31, v31
v_cvt_pk_bf16_f32 v54, v28, v29
ds_read_b128 v[76:79], v100 offset:3072
ds_read_b64 v[82:83], v101 offset:768
s_waitcnt lgkmcnt(2)
v_exp_f32 v32, v32
v_exp_f32 v33, v33
v_cvt_pk_bf16_f32 v55, v30, v31
v_exp_f32 v34, v34
v_exp_f32 v35, v35
v_mfma_f32_32x32x16_bf16 v[56:71], v[88:91], v[52:55], v[56:71]
ds_read_b128 v[84:87], v102 offset:2432
ds_read_b128 v[88:91], v102 offset:3040
v_cvt_pk_bf16_f32 v48, v32, v33
v_exp_f32 v36, v36
v_exp_f32 v37, v37
v_cvt_pk_bf16_f32 v49, v34, v35
v_exp_f32 v38, v38
v_mfma_f32_32x32x16_bf16 v[16:31], v[72:75], v[8:11], 0
v_exp_f32 v39, v39
v_cvt_pk_bf16_f32 v50, v36, v37
v_exp_f32 v40, v40
v_exp_f32 v41, v41
v_cvt_pk_bf16_f32 v51, v38, v39
v_exp_f32 v42, v42
v_mfma_f32_32x32x8bf16_1k v[16:31], v[80:81], v[12:13], v[16:31]
v_exp_f32 v43, v43
v_cvt_pk_bf16_f32 v52, v40, v41
v_exp_f32 v44, v44
v_exp_f32 v45, v45
v_mfma_f32_32x32x16_bf16 v[56:71], v[92:95], v[48:51], v[56:71]
v_cvt_pk_bf16_f32 v53, v42, v43
v_exp_f32 v46, v46
v_exp_f32 v47, v47
v_cvt_pk_bf16_f32 v54, v44, v45
s_waitcnt lgkmcnt(0)
s_nop 1
v_exp_f32 v16, v16
v_exp_f32 v17, v17
v_cvt_pk_bf16_f32 v55, v46, v47
v_exp_f32 v18, v18
v_exp_f32 v19, v19
v_mfma_f32_32x32x16_bf16 v[56:71], v[96:99], v[52:55], v[56:71]
ds_read_b128 v[92:95], v102 offset:3648
ds_read_b128 v[96:99], v102 offset:4256
v_cvt_pk_bf16_f32 v48, v16, v17
v_exp_f32 v20, v20
v_exp_f32 v21, v21
v_cvt_pk_bf16_f32 v49, v18, v19
v_exp_f32 v22, v22
v_mfma_f32_32x32x16_bf16 v[32:47], v[76:79], v[8:11], 0
v_exp_f32 v23, v23
v_cvt_pk_bf16_f32 v50, v20, v21
v_exp_f32 v24, v24
v_exp_f32 v25, v25
v_cvt_pk_bf16_f32 v51, v22, v23
v_exp_f32 v26, v26
v_mfma_f32_32x32x8bf16_1k v[32:47], v[82:83], v[12:13], v[32:47]
v_exp_f32 v27, v27
v_cvt_pk_bf16_f32 v52, v24, v25
v_exp_f32 v28, v28
v_exp_f32 v29, v29
v_mfma_f32_32x32x16_bf16 v[56:71], v[84:87], v[48:51], v[56:71]
v_cvt_pk_bf16_f32 v53, v26, v27
v_exp_f32 v30, v30
v_exp_f32 v31, v31
v_cvt_pk_bf16_f32 v54, v28, v29
s_waitcnt lgkmcnt(0)
s_nop 1
v_exp_f32 v32, v32
v_exp_f32 v33, v33
v_cvt_pk_bf16_f32 v55, v30, v31
v_exp_f32 v34, v34
v_exp_f32 v35, v35
v_mfma_f32_32x32x16_bf16 v[56:71], v[88:91], v[52:55], v[56:71]
v_cvt_pk_bf16_f32 v48, v32, v33
v_exp_f32 v36, v36
v_exp_f32 v37, v37
v_cvt_pk_bf16_f32 v49, v34, v35
v_exp_f32 v38, v38
v_exp_f32 v39, v39
v_cvt_pk_bf16_f32 v50, v36, v37
v_exp_f32 v40, v40
v_exp_f32 v41, v41
v_cvt_pk_bf16_f32 v51, v38, v39
v_exp_f32 v42, v42
v_exp_f32 v43, v43
v_cvt_pk_bf16_f32 v52, v40, v41
v_exp_f32 v44, v44
v_exp_f32 v45, v45
v_mfma_f32_32x32x16_bf16 v[56:71], v[92:95], v[48:51], v[56:71]
v_cvt_pk_bf16_f32 v53, v42, v43
v_exp_f32 v46, v46
v_exp_f32 v47, v47
v_cvt_pk_bf16_f32 v54, v44, v45
s_nop 0
v_cvt_pk_bf16_f32 v55, v46, v47
s_nop 1
v_mfma_f32_32x32x16_bf16 v[56:71], v[96:99], v[52:55], v[56:71]
s_cmp_lg_u32 s34, 0
s_cbranch_scc1 k3_final
s_nop 9
v_add_f32 v104, |v56|, |v57|
v_add_f32 v104, v104, |v58|
v_add_f32 v104, v104, |v59|
v_add_f32 v104, v104, |v60|
v_add_f32 v104, v104, |v61|
v_add_f32 v104, v104, |v62|
v_add_f32 v104, v104, |v63|
v_add_f32 v104, v104, |v64|
v_add_f32 v104, v104, |v65|
v_add_f32 v104, v104, |v66|
v_add_f32 v104, v104, |v67|
v_add_f32 v104, v104, |v68|
v_add_f32 v104, v104, |v69|
v_add_f32 v104, v104, |v70|
v_add_f32 v104, v104, |v71|
v_mov_b32 v105, 0x7e800000
v_cmp_nlt_f32 vcc, v104, v105
s_nop 0
s_cmp_eq_u64 vcc, 0
s_cbranch_scc1 k3_final
s_mov_b32 s34, 1
v_mov_b32 v13, 0
v_mov_b32 v100, v2
v_lshlrev_b32 v101, 3, v3
v_add_u32 v101, 65536, v101
v_mov_b32 v104, 0xff800000
s_mov_b32 s33, 64
k3_maxloop:
ds_read_b128 v[72:75], v100 offset:0
ds_read_b64 v[80:81], v101 offset:0
s_waitcnt lgkmcnt(0)
v_mfma_f32_32x32x16_bf16 v[16:31], v[72:75], v[8:11], 0
v_mfma_f32_32x32x8bf16_1k v[16:31], v[80:81], v[12:13], v[16:31]
s_nop 11
v_max3_f32 v104, v16, v17, v104
v_max3_f32 v104, v18, v19, v104
v_max3_f32 v104, v20, v21, v104
v_max3_f32 v104, v22, v23, v104
v_max3_f32 v104, v24, v25, v104
v_max3_f32 v104, v26, v27, v104
v_max3_f32 v104, v28, v29, v104
v_max3_f32 v104, v30, v31, v104
v_add_u32 v100, 1024, v100
v_add_u32 v101, 256, v101
s_sub_u32 s33, s33, 1
s_cmp_lg_u32 s33, 0
s_cbranch_scc1 k3_maxloop
v_mov_b32 v105, v104
s_nop 1
v_permlane32_swap_b32 v104, v105
v_max_f32 v104, v104, v105
v_sub_f32 v104, 0, v104
v_cvt_pk_bf16_f32 v104, v104, 0
v_and_b32 v104, 0xffff, v104
v_cmp_eq_u32 vcc, 0, v4
s_nop 1
v_cndmask_b32 v13, 0, v104, vcc
s_branch k3_pass
k3_final:
s_add_u32 s8, s20, 0x1c00000
s_addc_u32 s9, s21, 0
s_mov_b32 s10, 0x200000
s_mov_b32 s11, 0x00020000
s_add_u32 s12, s20, 0x1e00000
s_addc_u32 s13, s21, 0
s_mov_b32 s14, 0x40000
s_mov_b32 s15, 0x00020000
s_nop 1
v_mov_b32 v104, v66
v_mov_b32 v105, v66
s_nop 1
v_permlane32_swap_b32 v104, v105
v_rcp_f32 v104, v104
s_nop 0
v_mul_f32 v56, v56, v104
v_mul_f32 v57, v57, v104
v_mul_f32 v58, v58, v104
v_mul_f32 v59, v59, v104
v_mul_f32 v60, v60, v104
v_mul_f32 v61, v61, v104
v_mul_f32 v62, v62, v104
v_mul_f32 v63, v63, v104
v_mul_f32 v64, v64, v104
v_mul_f32 v65, v65, v104
v_cvt_pk_bf16_f32 v48, v56, v57
v_cvt_pk_bf16_f32 v49, v58, v59
v_cvt_pk_bf16_f32 v50, v60, v61
v_cvt_pk_bf16_f32 v51, v62, v63
v_cvt_pk_bf16_f32 v52, v64, v65
v_permlane32_swap_b32 v48, v50
v_permlane32_swap_b32 v49, v51
s_lshl_b32 s26, s23, 16
s_lshl_b32 s27, s25, 10
s_add_u32 s26, s26, s27
buffer_store_dwordx4 v[48:51], v2, s[8:11], s26 offen sc0 sc1
s_lshl_b32 s26, s23, 13
s_lshl_b32 s27, s25, 7
s_add_u32 s26, s26, s27
v_lshlrev_b32 v5, 2, v3
v_cmp_eq_u32 vcc, 0, v4
s_nop 0
s_and_saveexec_b64 s[36:37], vcc
buffer_store_dword v52, v5, s[12:15], s26 offen sc0 sc1
s_mov_b64 exec, s[36:37]
s_branch k3_proj
k3_helper:
s_setprio 2
s_load_dwordx2 s[4:5], s[0:1], 32
s_load_dwordx2 s[6:7], s[0:1], 40
s_load_dwordx2 s[42:43], s[0:1], 48
v_and_b32 v7, 63, v0
v_lshlrev_b32 v4, 4, v7
v_lshrrev_b32 v5, 4, v7
v_and_b32 v7, 15, v7
v_mul_u32_u24 v6, 36864, v5
v_mad_u32_u24 v6, v7, 12, v6
v_mul_u32_u24 v5, 73728, v5
v_lshl_add_u32 v5, v7, 4, v5
s_mov_b32 s40, 0x05040100
s_mov_b32 s41, 0x07060302
s_lshl_b32 s23, s2, 2
s_add_u32 s23, s23, s22
s_sub_u32 s23, s23, 8
s_waitcnt lgkmcnt(0)
s_mov_b32 s8, s4
s_mov_b32 s9, s5
s_mov_b32 s10, 0x510000
s_mov_b32 s11, 0x00020000
s_mov_b32 s12, s6
s_mov_b32 s13, s7
s_mov_b32 s14, 0x510000
s_mov_b32 s15, 0x00020000
s_add_u32 s16, s20, 0x300000
s_addc_u32 s17, s21, 0
s_mov_b32 s18, 0xa20000
s_mov_b32 s19, 0x00020000
s_mov_b32 s44, s42
s_mov_b32 s45, s43
s_mov_b32 s46, 0x510000
s_mov_b32 s47, 0x00020000
s_add_u32 s48, s20, 0xe00000
s_addc_u32 s49, s21, 0
s_mov_b32 s50, 0x510000
s_mov_b32 s51, 0x00020000
s_add_u32 s52, s20, 0x1700000
s_addc_u32 s53, s21, 0
s_mov_b32 s54, 0x4e0000
s_mov_b32 s55, 0x00020000
s_barrier
s_and_b32 s26, s2, 31
s_mul_i32 s28, s26, 159744
s_sub_u32 s35, s22, 8
s_mov_b32 s33, 30
k3_hdma:
s_min_u32 s29, s35, 116
s_cmp_ge_u32 s29, 48
s_cselect_b32 s31, 4, 0
s_add_u32 s31, s31, 16
s_cmp_ge_u32 s29, 60
s_cselect_b32 s30, 19, 0
s_add_u32 s29, s29, s31
s_add_u32 s29, s29, s30
s_lshl_b32 s29, s29, 10
s_mov_b32 m0, s29
s_add_u32 s30, s28, s29
buffer_load_dwordx4 v4, s[52:55], s30 offen lds
s_add_u32 s35, s35, 4
s_sub_u32 s33, s33, 1
s_cmp_lg_u32 s33, 0
s_cbranch_scc1 k3_hdma
s_mul_hi_u32 s25, s23, 0x6522c4
s_mul_i32 s27, s25, 648
s_sub_u32 s26, s23, s27
s_mul_hi_u32 s27, s26, 0xe38e38f
s_mul_i32 s29, s27, 18
s_sub_u32 s28, s26, s29
s_mul_i32 s29, s28, 294912
s_lshl_b32 s30, s27, 8
s_add_u32 s29, s29, s30
s_cmp_eq_u32 s25, 1
s_cbranch_scc1 k3h0_w3
buffer_load_dwordx4 v[8:11], v5, s[8:11], s29 offen
s_add_u32 s29, s29, 9216
buffer_load_dwordx4 v[12:15], v5, s[8:11], s29 offen
s_add_u32 s29, s29, 9216
buffer_load_dwordx4 v[16:19], v5, s[8:11], s29 offen
s_add_u32 s29, s29, 9216
buffer_load_dwordx4 v[20:23], v5, s[8:11], s29 offen
s_add_u32 s29, s29, 9216
buffer_load_dwordx4 v[24:27], v5, s[8:11], s29 offen
s_add_u32 s29, s29, 9216
buffer_load_dwordx4 v[28:31], v5, s[8:11], s29 offen
s_add_u32 s29, s29, 9216
buffer_load_dwordx4 v[32:35], v5, s[8:11], s29 offen
s_add_u32 s29, s29, 9216
buffer_load_dwordx4 v[36:39], v5, s[8:11], s29 offen
s_branch k3h0_j
k3h0_w3:
buffer_load_dwordx4 v[8:11], v5, s[12:15], s29 offen
s_add_u32 s29, s29, 9216
buffer_load_dwordx4 v[12:15], v5, s[12:15], s29 offen
s_add_u32 s29, s29, 9216
buffer_load_dwordx4 v[16:19], v5, s[12:15], s29 offen
s_add_u32 s29, s29, 9216
buffer_load_dwordx4 v[20:23], v5, s[12:15], s29 offen
s_add_u32 s29, s29, 9216
buffer_load_dwordx4 v[24:27], v5, s[12:15], s29 offen
s_add_u32 s29, s29, 9216
buffer_load_dwordx4 v[28:31], v5, s[12:15], s29 offen
s_add_u32 s29, s29, 9216
buffer_load_dwordx4 v[32:35], v5, s[12:15], s29 offen
s_add_u32 s29, s29, 9216
buffer_load_dwordx4 v[36:39], v5, s[12:15], s29 offen
k3h0_j:
s_mul_hi_u32 s30, s27, 0x55555556
s_mul_i32 s33, s30, 3
s_sub_u32 s31, s27, s33
s_mul_i32 s30, s30, 110592
s_mul_i32 s33, s28, 6144
s_add_u32 s30, s30, s33
s_lshl_b32 s31, s31, 1
s_add_u32 s31, s31, s25
s_lshl_b32 s31, s31, 10
s_add_u32 s34, s30, s31
s_waitcnt vmcnt(8)
v_mov_b32 v110, 159744
v_mov_b32 v111, 1
s_mov_b64 exec, 1
ds_add_u32 v110, v111
s_mov_b64 exec, -1
s_add_u32 s52, s20, 0x3700000
s_addc_u32 s53, s21, 0
s_mov_b32 s54, 0x310000
s_mov_b32 s55, 0x00020000
v_mov_b32 v112, -1
v_mov_b32 v113, -1
v_mov_b32 v114, -1
v_mov_b32 v115, -1
s_mul_i32 s26, s23, 2304
buffer_store_dwordx4 v[112:115], v4, s[52:55], s26 offen sc0 sc1
buffer_store_dwordx4 v[112:115], v4, s[52:55], s26 offen offset:1024 sc0 sc1
s_mov_b64 exec, 0xffff
buffer_store_dwordx4 v[112:115], v4, s[52:55], s26 offen offset:2048 sc0 sc1
s_lshl_b32 s26, s23, 6
s_add_u32 s26, s26, 0x300000
s_mov_b64 exec, 0xf
buffer_store_dwordx4 v[112:115], v4, s[52:55], s26 offen sc0 sc1
s_mov_b64 exec, -1
s_cmp_ge_u32 s23, 272
s_cbranch_scc1 k3_hb
s_add_u32 s24, s23, 1024
s_mul_hi_u32 s25, s24, 0x6522c4
s_mul_i32 s27, s25, 648
s_sub_u32 s26, s24, s27
s_mul_hi_u32 s27, s26, 0xe38e38f
s_mul_i32 s29, s27, 18
s_sub_u32 s28, s26, s29
s_mul_i32 s29, s28, 294912
s_lshl_b32 s30, s27, 8
s_add_u32 s29, s29, s30
s_cmp_eq_u32 s25, 1
s_cbranch_scc1 k3h1_w3
buffer_load_dwordx4 v[40:43], v5, s[8:11], s29 offen
s_add_u32 s29, s29, 9216
buffer_load_dwordx4 v[44:47], v5, s[8:11], s29 offen
s_add_u32 s29, s29, 9216
buffer_load_dwordx4 v[48:51], v5, s[8:11], s29 offen
s_add_u32 s29, s29, 9216
buffer_load_dwordx4 v[52:55], v5, s[8:11], s29 offen
s_add_u32 s29, s29, 9216
buffer_load_dwordx4 v[56:59], v5, s[8:11], s29 offen
s_add_u32 s29, s29, 9216
buffer_load_dwordx4 v[60:63], v5, s[8:11], s29 offen
s_add_u32 s29, s29, 9216
buffer_load_dwordx4 v[64:67], v5, s[8:11], s29 offen
s_add_u32 s29, s29, 9216
buffer_load_dwordx4 v[68:71], v5, s[8:11], s29 offen
s_branch k3h1_j
k3h1_w3:
buffer_load_dwordx4 v[40:43], v5, s[12:15], s29 offen
s_add_u32 s29, s29, 9216
buffer_load_dwordx4 v[44:47], v5, s[12:15], s29 offen
s_add_u32 s29, s29, 9216
buffer_load_dwordx4 v[48:51], v5, s[12:15], s29 offen
s_add_u32 s29, s29, 9216
buffer_load_dwordx4 v[52:55], v5, s[12:15], s29 offen
s_add_u32 s29, s29, 9216
buffer_load_dwordx4 v[56:59], v5, s[12:15], s29 offen
s_add_u32 s29, s29, 9216
buffer_load_dwordx4 v[60:63], v5, s[12:15], s29 offen
s_add_u32 s29, s29, 9216
buffer_load_dwordx4 v[64:67], v5, s[12:15], s29 offen
s_add_u32 s29, s29, 9216
buffer_load_dwordx4 v[68:71], v5, s[12:15], s29 offen
k3h1_j:
s_mul_hi_u32 s30, s27, 0x55555556
s_mul_i32 s33, s30, 3
s_sub_u32 s31, s27, s33
s_mul_i32 s30, s30, 110592
s_mul_i32 s33, s28, 6144
s_add_u32 s30, s30, s33
s_lshl_b32 s31, s31, 1
s_add_u32 s31, s31, s25
s_lshl_b32 s31, s31, 10
s_add_u32 s35, s30, s31
s_waitcnt vmcnt(12)
v_perm_b32 v72, v12, v8, s40
v_perm_b32 v73, v20, v16, s40
v_perm_b32 v74, v28, v24, s40
v_perm_b32 v75, v36, v32, s40
buffer_store_dwordx4 v[72:75], v4, s[16:19], s34 offen sc0 sc1
s_add_u32 s34, s34, 1327104
v_perm_b32 v76, v12, v8, s41
v_perm_b32 v77, v20, v16, s41
v_perm_b32 v78, v28, v24, s41
v_perm_b32 v79, v36, v32, s41
buffer_store_dwordx4 v[76:79], v4, s[16:19], s34 offen sc0 sc1
s_add_u32 s34, s34, 1327104
v_perm_b32 v80, v13, v9, s40
v_perm_b32 v81, v21, v17, s40
v_perm_b32 v82, v29, v25, s40
v_perm_b32 v83, v37, v33, s40
buffer_store_dwordx4 v[80:83], v4, s[16:19], s34 offen sc0 sc1
s_add_u32 s34, s34, 1327104
v_perm_b32 v84, v13, v9, s41
v_perm_b32 v85, v21, v17, s41
v_perm_b32 v86, v29, v25, s41
v_perm_b32 v87, v37, v33, s41
buffer_store_dwordx4 v[84:87], v4, s[16:19], s34 offen sc0 sc1
s_add_u32 s34, s34, 1327104
v_perm_b32 v88, v14, v10, s40
v_perm_b32 v89, v22, v18, s40
v_perm_b32 v90, v30, v26, s40
v_perm_b32 v91, v38, v34, s40
buffer_store_dwordx4 v[88:91], v4, s[16:19], s34 offen sc0 sc1
s_add_u32 s34, s34, 1327104
v_perm_b32 v92, v14, v10, s41
v_perm_b32 v93, v22, v18, s41
v_perm_b32 v94, v30, v26, s41
v_perm_b32 v95, v38, v34, s41
buffer_store_dwordx4 v[92:95], v4, s[16:19], s34 offen sc0 sc1
s_add_u32 s34, s34, 1327104
v_perm_b32 v96, v15, v11, s40
v_perm_b32 v97, v23, v19, s40
v_perm_b32 v98, v31, v27, s40
v_perm_b32 v99, v39, v35, s40
buffer_store_dwordx4 v[96:99], v4, s[16:19], s34 offen sc0 sc1
s_add_u32 s34, s34, 1327104
v_perm_b32 v100, v15, v11, s41
v_perm_b32 v101, v23, v19, s41
v_perm_b32 v102, v31, v27, s41
v_perm_b32 v103, v39, v35, s41
buffer_store_dwordx4 v[100:103], v4, s[16:19], s34 offen sc0 sc1
s_waitcnt vmcnt(8)
v_perm_b32 v72, v44, v40, s40
v_perm_b32 v73, v52, v48, s40
v_perm_b32 v74, v60, v56, s40
v_perm_b32 v75, v68, v64, s40
buffer_store_dwordx4 v[72:75], v4, s[16:19], s35 offen sc0 sc1
s_add_u32 s35, s35, 1327104
v_perm_b32 v76, v44, v40, s41
v_perm_b32 v77, v52, v48, s41
v_perm_b32 v78, v60, v56, s41
v_perm_b32 v79, v68, v64, s41
buffer_store_dwordx4 v[76:79], v4, s[16:19], s35 offen sc0 sc1
s_add_u32 s35, s35, 1327104
v_perm_b32 v80, v45, v41, s40
v_perm_b32 v81, v53, v49, s40
v_perm_b32 v82, v61, v57, s40
v_perm_b32 v83, v69, v65, s40
buffer_store_dwordx4 v[80:83], v4, s[16:19], s35 offen sc0 sc1
s_add_u32 s35, s35, 1327104
v_perm_b32 v84, v45, v41, s41
v_perm_b32 v85, v53, v49, s41
v_perm_b32 v86, v61, v57, s41
v_perm_b32 v87, v69, v65, s41
buffer_store_dwordx4 v[84:87], v4, s[16:19], s35 offen sc0 sc1
s_add_u32 s35, s35, 1327104
v_perm_b32 v88, v46, v42, s40
v_perm_b32 v89, v54, v50, s40
v_perm_b32 v90, v62, v58, s40
v_perm_b32 v91, v70, v66, s40
buffer_store_dwordx4 v[88:91], v4, s[16:19], s35 offen sc0 sc1
s_add_u32 s35, s35, 1327104
v_perm_b32 v92, v46, v42, s41
v_perm_b32 v93, v54, v50, s41
v_perm_b32 v94, v62, v58, s41
v_perm_b32 v95, v70, v66, s41
buffer_store_dwordx4 v[92:95], v4, s[16:19], s35 offen sc0 sc1
s_add_u32 s35, s35, 1327104
v_perm_b32 v96, v47, v43, s40
v_perm_b32 v97, v55, v51, s40
v_perm_b32 v98, v63, v59, s40
v_perm_b32 v99, v71, v67, s40
buffer_store_dwordx4 v[96:99], v4, s[16:19], s35 offen sc0 sc1
s_add_u32 s35, s35, 1327104
v_perm_b32 v100, v47, v43, s41
v_perm_b32 v101, v55, v51, s41
v_perm_b32 v102, v63, v59, s41
v_perm_b32 v103, v71, v67, s41
buffer_store_dwordx4 v[100:103], v4, s[16:19], s35 offen sc0 sc1
s_branch k3_hdone
k3_hb:
s_sub_u32 s24, s23, 272
s_mul_hi_u32 s25, s24, 0x25ed098
s_mul_i32 s27, s25, 108
s_sub_u32 s26, s24, s27
s_mul_hi_u32 s27, s26, 0x2aaaaaab
s_mul_i32 s29, s27, 6
s_sub_u32 s28, s26, s29
s_lshl_b32 s29, s27, 8
s_add_u32 s29, s29, s25
s_mul_i32 s29, s29, 1152
s_mul_i32 s30, s28, 192
s_add_u32 s29, s29, s30
s_add_u32 s30, s29, 0
buffer_load_dwordx3 v[40:42], v6, s[44:47], s30 offen
s_add_u32 s30, s29, 9216
buffer_load_dwordx3 v[44:46], v6, s[44:47], s30 offen
s_add_u32 s30, s29, 18432
buffer_load_dwordx3 v[48:50], v6, s[44:47], s30 offen
s_add_u32 s30, s29, 27648
buffer_load_dwordx3 v[52:54], v6, s[44:47], s30 offen
s_add_u32 s30, s29, 147456
buffer_load_dwordx3 v[56:58], v6, s[44:47], s30 offen
s_add_u32 s30, s29, 156672
buffer_load_dwordx3 v[60:62], v6, s[44:47], s30 offen
s_add_u32 s30, s29, 165888
buffer_load_dwordx3 v[64:66], v6, s[44:47], s30 offen
s_add_u32 s30, s29, 175104
buffer_load_dwordx3 v[68:70], v6, s[44:47], s30 offen
s_mul_i32 s30, s25, 663552
s_mul_i32 s31, s28, 110592
s_add_u32 s30, s30, s31
s_mul_i32 s31, s27, 3072
s_add_u32 s35, s30, s31
s_waitcnt vmcnt(12)
v_perm_b32 v72, v12, v8, s40
v_perm_b32 v73, v20, v16, s40
v_perm_b32 v74, v28, v24, s40
v_perm_b32 v75, v36, v32, s40
buffer_store_dwordx4 v[72:75], v4, s[16:19], s34 offen sc0 sc1
s_add_u32 s34, s34, 1327104
v_perm_b32 v76, v12, v8, s41
v_perm_b32 v77, v20, v16, s41
v_perm_b32 v78, v28, v24, s41
v_perm_b32 v79, v36, v32, s41
buffer_store_dwordx4 v[76:79], v4, s[16:19], s34 offen sc0 sc1
s_add_u32 s34, s34, 1327104
v_perm_b32 v80, v13, v9, s40
v_perm_b32 v81, v21, v17, s40
v_perm_b32 v82, v29, v25, s40
v_perm_b32 v83, v37, v33, s40
buffer_store_dwordx4 v[80:83], v4, s[16:19], s34 offen sc0 sc1
s_add_u32 s34, s34, 1327104
v_perm_b32 v84, v13, v9, s41
v_perm_b32 v85, v21, v17, s41
v_perm_b32 v86, v29, v25, s41
v_perm_b32 v87, v37, v33, s41
buffer_store_dwordx4 v[84:87], v4, s[16:19], s34 offen sc0 sc1
s_add_u32 s34, s34, 1327104
v_perm_b32 v88, v14, v10, s40
v_perm_b32 v89, v22, v18, s40
v_perm_b32 v90, v30, v26, s40
v_perm_b32 v91, v38, v34, s40
buffer_store_dwordx4 v[88:91], v4, s[16:19], s34 offen sc0 sc1
s_add_u32 s34, s34, 1327104
v_perm_b32 v92, v14, v10, s41
v_perm_b32 v93, v22, v18, s41
v_perm_b32 v94, v30, v26, s41
v_perm_b32 v95, v38, v34, s41
buffer_store_dwordx4 v[92:95], v4, s[16:19], s34 offen sc0 sc1
s_add_u32 s34, s34, 1327104
v_perm_b32 v96, v15, v11, s40
v_perm_b32 v97, v23, v19, s40
v_perm_b32 v98, v31, v27, s40
v_perm_b32 v99, v39, v35, s40
buffer_store_dwordx4 v[96:99], v4, s[16:19], s34 offen sc0 sc1
s_add_u32 s34, s34, 1327104
v_perm_b32 v100, v15, v11, s41
v_perm_b32 v101, v23, v19, s41
v_perm_b32 v102, v31, v27, s41
v_perm_b32 v103, v39, v35, s41
buffer_store_dwordx4 v[100:103], v4, s[16:19], s34 offen sc0 sc1
s_cmp_ge_u32 s23, 384
s_cbranch_scc1 k3_hc
s_add_u32 s24, s23, 480
s_mul_hi_u32 s25, s24, 0x25ed098
s_mul_i32 s27, s25, 108
s_sub_u32 s26, s24, s27
s_mul_hi_u32 s27, s26, 0x2aaaaaab
s_mul_i32 s29, s27, 6
s_sub_u32 s28, s26, s29
s_lshl_b32 s29, s27, 8
s_add_u32 s29, s29, s25
s_mul_i32 s29, s29, 1152
s_mul_i32 s30, s28, 192
s_add_u32 s29, s29, s30
s_add_u32 s30, s29, 0
buffer_load_dwordx3 v[8:10], v6, s[44:47], s30 offen
s_add_u32 s30, s29, 9216
buffer_load_dwordx3 v[12:14], v6, s[44:47], s30 offen
s_add_u32 s30, s29, 18432
buffer_load_dwordx3 v[16:18], v6, s[44:47], s30 offen
s_add_u32 s30, s29, 27648
buffer_load_dwordx3 v[20:22], v6, s[44:47], s30 offen
s_add_u32 s30, s29, 147456
buffer_load_dwordx3 v[24:26], v6, s[44:47], s30 offen
s_add_u32 s30, s29, 156672
buffer_load_dwordx3 v[28:30], v6, s[44:47], s30 offen
s_add_u32 s30, s29, 165888
buffer_load_dwordx3 v[32:34], v6, s[44:47], s30 offen
s_add_u32 s30, s29, 175104
buffer_load_dwordx3 v[36:38], v6, s[44:47], s30 offen
s_mul_i32 s30, s25, 663552
s_mul_i32 s31, s28, 110592
s_add_u32 s30, s30, s31
s_mul_i32 s31, s27, 3072
s_add_u32 s34, s30, s31
s_waitcnt vmcnt(16)
v_perm_b32 v72, v44, v40, s40
v_perm_b32 v73, v52, v48, s40
v_perm_b32 v74, v60, v56, s40
v_perm_b32 v75, v68, v64, s40
s_add_u32 s31, s35, 0
buffer_store_dwordx4 v[72:75], v4, s[48:51], s31 offen sc0 sc1
v_perm_b32 v76, v44, v40, s41
v_perm_b32 v77, v52, v48, s41
v_perm_b32 v78, v60, v56, s41
v_perm_b32 v79, v68, v64, s41
s_add_u32 s31, s35, 1024
buffer_store_dwordx4 v[76:79], v4, s[48:51], s31 offen sc0 sc1
v_perm_b32 v80, v45, v41, s40
v_perm_b32 v81, v53, v49, s40
v_perm_b32 v82, v61, v57, s40
v_perm_b32 v83, v69, v65, s40
s_add_u32 s31, s35, 2048
buffer_store_dwordx4 v[80:83], v4, s[48:51], s31 offen sc0 sc1
v_perm_b32 v84, v45, v41, s41
v_perm_b32 v85, v53, v49, s41
v_perm_b32 v86, v61, v57, s41
v_perm_b32 v87, v69, v65, s41
s_add_u32 s31, s35, 55296
buffer_store_dwordx4 v[84:87], v4, s[48:51], s31 offen sc0 sc1
v_perm_b32 v88, v46, v42, s40
v_perm_b32 v89, v54, v50, s40
v_perm_b32 v90, v62, v58, s40
v_perm_b32 v91, v70, v66, s40
s_add_u32 s31, s35, 56320
buffer_store_dwordx4 v[88:91], v4, s[48:51], s31 offen sc0 sc1
v_perm_b32 v92, v46, v42, s41
v_perm_b32 v93, v54, v50, s41
v_perm_b32 v94, v62, v58, s41
v_perm_b32 v95, v70, v66, s41
s_add_u32 s31, s35, 57344
buffer_store_dwordx4 v[92:95], v4, s[48:51], s31 offen sc0 sc1
s_waitcnt vmcnt(6)
v_perm_b32 v72, v12, v8, s40
v_perm_b32 v73, v20, v16, s40
v_perm_b32 v74, v28, v24, s40
v_perm_b32 v75, v36, v32, s40
s_add_u32 s31, s34, 0
buffer_store_dwordx4 v[72:75], v4, s[48:51], s31 offen sc0 sc1
v_perm_b32 v76, v12, v8, s41
v_perm_b32 v77, v20, v16, s41
v_perm_b32 v78, v28, v24, s41
v_perm_b32 v79, v36, v32, s41
s_add_u32 s31, s34, 1024
buffer_store_dwordx4 v[76:79], v4, s[48:51], s31 offen sc0 sc1
v_perm_b32 v80, v13, v9, s40
v_perm_b32 v81, v21, v17, s40
v_perm_b32 v82, v29, v25, s40
v_perm_b32 v83, v37, v33, s40
s_add_u32 s31, s34, 2048
buffer_store_dwordx4 v[80:83], v4, s[48:51], s31 offen sc0 sc1
v_perm_b32 v84, v13, v9, s41
v_perm_b32 v85, v21, v17, s41
v_perm_b32 v86, v29, v25, s41
v_perm_b32 v87, v37, v33, s41
s_add_u32 s31, s34, 55296
buffer_store_dwordx4 v[84:87], v4, s[48:51], s31 offen sc0 sc1
v_perm_b32 v88, v14, v10, s40
v_perm_b32 v89, v22, v18, s40
v_perm_b32 v90, v30, v26, s40
v_perm_b32 v91, v38, v34, s40
s_add_u32 s31, s34, 56320
buffer_store_dwordx4 v[88:91], v4, s[48:51], s31 offen sc0 sc1
v_perm_b32 v92, v14, v10, s41
v_perm_b32 v93, v22, v18, s41
v_perm_b32 v94, v30, v26, s41
v_perm_b32 v95, v38, v34, s41
s_add_u32 s31, s34, 57344
buffer_store_dwordx4 v[92:95], v4, s[48:51], s31 offen sc0 sc1
s_branch k3_hdone
k3_hc:
s_waitcnt vmcnt(8)
v_perm_b32 v72, v44, v40, s40
v_perm_b32 v73, v52, v48, s40
v_perm_b32 v74, v60, v56, s40
v_perm_b32 v75, v68, v64, s40
s_add_u32 s31, s35, 0
buffer_store_dwordx4 v[72:75], v4, s[48:51], s31 offen sc0 sc1
v_perm_b32 v76, v44, v40, s41
v_perm_b32 v77, v52, v48, s41
v_perm_b32 v78, v60, v56, s41
v_perm_b32 v79, v68, v64, s41
s_add_u32 s31, s35, 1024
buffer_store_dwordx4 v[76:79], v4, s[48:51], s31 offen sc0 sc1
v_perm_b32 v80, v45, v41, s40
v_perm_b32 v81, v53, v49, s40
v_perm_b32 v82, v61, v57, s40
v_perm_b32 v83, v69, v65, s40
s_add_u32 s31, s35, 2048
buffer_store_dwordx4 v[80:83], v4, s[48:51], s31 offen sc0 sc1
v_perm_b32 v84, v45, v41, s41
v_perm_b32 v85, v53, v49, s41
v_perm_b32 v86, v61, v57, s41
v_perm_b32 v87, v69, v65, s41
s_add_u32 s31, s35, 55296
buffer_store_dwordx4 v[84:87], v4, s[48:51], s31 offen sc0 sc1
v_perm_b32 v88, v46, v42, s40
v_perm_b32 v89, v54, v50, s40
v_perm_b32 v90, v62, v58, s40
v_perm_b32 v91, v70, v66, s40
s_add_u32 s31, s35, 56320
buffer_store_dwordx4 v[88:91], v4, s[48:51], s31 offen sc0 sc1
v_perm_b32 v92, v46, v42, s41
v_perm_b32 v93, v54, v50, s41
v_perm_b32 v94, v62, v58, s41
v_perm_b32 v95, v70, v66, s41
s_add_u32 s31, s35, 57344
buffer_store_dwordx4 v[92:95], v4, s[48:51], s31 offen sc0 sc1
k3_hdone:
s_setprio 0
s_waitcnt vmcnt(0)
s_add_u32 s52, s20, 0x3b00000
s_addc_u32 s53, s21, 0
s_mov_b32 s54, 0x20000
s_mov_b32 s55, 0x00020000
v_mov_b32 v6, 159752
v_mov_b32 v7, 1
s_mov_b64 exec, 1
ds_add_rtn_u32 v8, v6, v7
s_waitcnt lgkmcnt(0)
v_readfirstlane_b32 s26, v8
s_nop 0
s_cmp_lg_u32 s26, 3
s_cbranch_scc1 k3_hnosig
s_and_b32 s26, s2, 7
s_add_u32 s26, s26, 128
s_lshl_b32 s26, s26, 9
v_mov_b32 v6, s26
buffer_atomic_add v7, v6, s[52:55], 0 offen sc1
k3_hnosig:
s_mov_b64 exec, -1
s_mov_b32 s58, 0
s_cmp_eq_u32 s22, 8
s_cbranch_scc1 k3_proj
s_barrier
s_barrier
s_barrier
s_branch k3_ffn
s_cmp_lg_u32 s22, 8
s_cbranch_scc1 k3_exit
s_mov_b32 s58, 0
k3_proj:
s_and_b32 s26, s2, 31
s_lshr_b32 s56, s2, 5
s_lshr_b32 s23, s26, 3
s_and_b32 s24, s26, 7
s_lshl_b32 s27, s56, 3
s_add_u32 s24, s24, s27
s_load_dwordx2 s[4:5], s[0:1], 0
v_and_b32 v1, 63, v0
v_and_b32 v2, 15, v1
v_lshrrev_b32 v3, 4, v1
v_lshlrev_b32 v4, 4, v1
s_waitcnt lgkmcnt(0)
s_add_u32 s8, s20, 0x1c00000
s_addc_u32 s9, s21, 0
s_mov_b32 s10, 0x200000
s_mov_b32 s11, 0x00020000
s_add_u32 s12, s20, 0x1e00000
s_addc_u32 s13, s21, 0
s_mov_b32 s14, 0x40000
s_mov_b32 s15, 0x00020000
s_add_u32 s16, s20, 0x200000
s_addc_u32 s17, s21, 0
s_mov_b32 s18, 0xa2000
s_mov_b32 s19, 0x00020000
s_mov_b32 s44, s4
s_mov_b32 s45, s5
s_mov_b32 s46, 0x240000
s_mov_b32 s47, 0x00020000
s_mov_b32 s48, s20
s_mov_b32 s49, s21
s_mov_b32 s50, 0x3600
s_mov_b32 s51, 0x00020000
s_add_u32 s52, s20, 0x3b00000
s_addc_u32 s53, s21, 0
s_mov_b32 s54, 0x20000
s_mov_b32 s55, 0x00020000
s_mul_i32 s25, s23, 9
s_add_u32 s25, s25, s22
s_mul_i32 s43, s25, 18432
s_mul_i32 s43, s25, 18432
buffer_load_dwordx4 v[28:31], v4, s[16:19], s43 offen offset:0
buffer_load_dwordx4 v[32:35], v4, s[16:19], s43 offen offset:1024
buffer_load_dwordx4 v[36:39], v4, s[16:19], s43 offen offset:2048
buffer_load_dwordx4 v[40:43], v4, s[16:19], s43 offen offset:3072
s_add_u32 s43, s43, 4096
buffer_load_dwordx4 v[44:47], v4, s[16:19], s43 offen offset:0
buffer_load_dwordx4 v[48:51], v4, s[16:19], s43 offen offset:1024
buffer_load_dwordx4 v[52:55], v4, s[16:19], s43 offen offset:2048
buffer_load_dwordx4 v[56:59], v4, s[16:19], s43 offen offset:3072
s_add_u32 s43, s43, 4096
buffer_load_dwordx4 v[60:63], v4, s[16:19], s43 offen offset:0
buffer_load_dwordx4 v[64:67], v4, s[16:19], s43 offen offset:1024
buffer_load_dwordx4 v[68:71], v4, s[16:19], s43 offen offset:2048
buffer_load_dwordx4 v[72:75], v4, s[16:19], s43 offen offset:3072
s_add_u32 s43, s43, 4096
buffer_load_dwordx4 v[76:79], v4, s[16:19], s43 offen offset:0
buffer_load_dwordx4 v[80:83], v4, s[16:19], s43 offen offset:1024
buffer_load_dwordx4 v[84:87], v4, s[16:19], s43 offen offset:2048
buffer_load_dwordx4 v[88:91], v4, s[16:19], s43 offen offset:3072
s_add_u32 s43, s43, 4096
buffer_load_dwordx4 v[92:95], v4, s[16:19], s43 offen offset:0
buffer_load_dwordx4 v[96:99], v4, s[16:19], s43 offen offset:1024
v_mul_u32_u24 v6, 1152, v2
v_lshl_add_u32 v6, v3, 3, v6
s_mul_i32 s27, s24, 36864
s_lshl_b32 s26, s25, 5
s_add_u32 s27, s27, s26
buffer_load_dwordx2 v[108:109], v6, s[44:47], s27 offen
s_add_u32 s26, s27, 18432
buffer_load_dwordx2 v[110:111], v6, s[44:47], s26 offen
v_lshlrev_b32 v7, 4, v3
s_lshl_b32 s26, s25, 6
s_add_u32 s26, s26, 4608
buffer_load_dwordx4 v[112:115], v7, s[48:51], s26 offen
k3p_late:
s_barrier
s_mov_b32 s57, 20000
v_and_b32 v9, 7, v1
v_add_u32 v9, 128, v9
v_lshlrev_b32 v9, 9, v9
v_mov_b32 v10, 32
k3p_retry:
s_cmp_lg_u32 s22, 1
s_cbranch_scc1 k3p_nocw
buffer_load_dword v10, v9, s[52:55], 0 offen sc0 sc1
k3p_nocw:
s_cmp_eq_u32 s22, 8
s_cbranch_scc1 k3p_ext
v_lshrrev_b32 v5, 1, v3
v_lshlrev_b32 v5, 16, v5
v_and_b32 v6, 1, v3
v_lshl_add_u32 v5, v6, 9, v5
v_lshl_add_u32 v5, v2, 4, v5
s_lshl_b32 s40, s22, 18
s_lshl_b32 s26, s24, 10
s_add_u32 s40, s40, s26
s_add_u32 s26, s40, 0
buffer_load_dwordx4 v[12:15], v5, s[8:11], s26 offen sc1
s_add_u32 s26, s40, 256
buffer_load_dwordx4 v[16:19], v5, s[8:11], s26 offen sc1
s_add_u32 s26, s40, 131072
buffer_load_dwordx4 v[20:23], v5, s[8:11], s26 offen sc1
s_add_u32 s26, s40, 131328
buffer_load_dwordx4 v[24:27], v5, s[8:11], s26 offen sc1
s_branch k3p_j
k3p_ext:
v_lshlrev_b32 v5, 15, v3
v_lshl_add_u32 v5, v2, 2, v5
s_lshl_b32 s40, s24, 7
s_add_u32 s26, s40, 0
buffer_load_dword v12, v5, s[12:15], s26 offen sc1
s_add_u32 s26, s40, 8192
buffer_load_dword v13, v5, s[12:15], s26 offen sc1
s_add_u32 s26, s40, 16384
buffer_load_dword v14, v5, s[12:15], s26 offen sc1
s_add_u32 s26, s40, 24576
buffer_load_dword v15, v5, s[12:15], s26 offen sc1
s_add_u32 s26, s40, 64
buffer_load_dword v16, v5, s[12:15], s26 offen sc1
s_add_u32 s26, s40, 8256
buffer_load_dword v17, v5, s[12:15], s26 offen sc1
s_add_u32 s26, s40, 16448
buffer_load_dword v18, v5, s[12:15], s26 offen sc1
s_add_u32 s26, s40, 24640
buffer_load_dword v19, v5, s[12:15], s26 offen sc1
s_add_u32 s26, s40, 131072
buffer_load_dword v20, v5, s[12:15], s26 offen sc1
s_add_u32 s26, s40, 139264
buffer_load_dword v21, v5, s[12:15], s26 offen sc1
s_add_u32 s26, s40, 147456
buffer_load_dword v22, v5, s[12:15], s26 offen sc1
s_add_u32 s26, s40, 155648
buffer_load_dword v23, v5, s[12:15], s26 offen sc1
s_add_u32 s26, s40, 131136
buffer_load_dword v24, v5, s[12:15], s26 offen sc1
s_add_u32 s26, s40, 139328
buffer_load_dword v25, v5, s[12:15], s26 offen sc1
s_add_u32 s26, s40, 147520
buffer_load_dword v26, v5, s[12:15], s26 offen sc1
s_add_u32 s26, s40, 155712
buffer_load_dword v27, v5, s[12:15], s26 offen sc1
k3p_j:
s_waitcnt vmcnt(0)
k3p_chk:
v_max3_u32 v8, v12, v13, v14
v_max3_u32 v8, v15, v16, v8
v_max3_u32 v8, v17, v18, v8
v_max3_u32 v8, v19, v20, v8
v_max3_u32 v8, v21, v22, v8
v_max3_u32 v8, v23, v24, v8
v_max3_u32 v8, v25, v26, v8
v_max_u32 v8, v27, v8
v_cmp_eq_u32 vcc, -1, v8
s_nop 0
s_mov_b64 s[40:41], vcc
v_cmp_gt_u32 vcc, 32, v10
s_nop 0
s_or_b64 vcc, vcc, s[40:41]
s_sub_u32 s57, s57, 1
s_cmp_eq_u32 s57, 0
s_cbranch_scc1 k3p_got
s_cmp_lg_u64 vcc, 0
s_cbranch_scc1 k3p_retry
k3p_got:
s_lshl_b32 s26, s22, 12
v_add_u32 v7, s26, v4
ds_write_b128 v7, v[12:15] offset:0
ds_write_b128 v7, v[16:19] offset:1024
ds_write_b128 v7, v[20:23] offset:2048
ds_write_b128 v7, v[24:27] offset:3072
s_waitcnt lgkmcnt(0)
s_barrier
s_waitcnt vmcnt(0)
ds_read_b128 v[128:131], v4 offset:0
ds_read_b128 v[132:135], v4 offset:1024
ds_read_b128 v[136:139], v4 offset:2048
ds_read_b128 v[140:143], v4 offset:3072
s_waitcnt lgkmcnt(2)
v_mfma_f32_16x16x32_bf16 v[100:103], v[28:31], v[128:131], 0
v_mfma_f32_16x16x32_bf16 v[104:107], v[28:31], v[132:135], 0
ds_read_b128 v[128:131], v4 offset:4096
ds_read_b128 v[132:135], v4 offset:5120
s_waitcnt lgkmcnt(2)
v_mfma_f32_16x16x32_bf16 v[100:103], v[32:35], v[136:139], v[100:103]
v_mfma_f32_16x16x32_bf16 v[104:107], v[32:35], v[140:143], v[104:107]
ds_read_b128 v[136:139], v4 offset:6144
ds_read_b128 v[140:143], v4 offset:7168
s_waitcnt lgkmcnt(2)
v_mfma_f32_16x16x32_bf16 v[100:103], v[36:39], v[128:131], v[100:103]
v_mfma_f32_16x16x32_bf16 v[104:107], v[36:39], v[132:135], v[104:107]
ds_read_b128 v[128:131], v4 offset:8192
ds_read_b128 v[132:135], v4 offset:9216
s_waitcnt lgkmcnt(2)
v_mfma_f32_16x16x32_bf16 v[100:103], v[40:43], v[136:139], v[100:103]
v_mfma_f32_16x16x32_bf16 v[104:107], v[40:43], v[140:143], v[104:107]
ds_read_b128 v[136:139], v4 offset:10240
ds_read_b128 v[140:143], v4 offset:11264
s_waitcnt lgkmcnt(2)
v_mfma_f32_16x16x32_bf16 v[100:103], v[44:47], v[128:131], v[100:103]
v_mfma_f32_16x16x32_bf16 v[104:107], v[44:47], v[132:135], v[104:107]
ds_read_b128 v[128:131], v4 offset:12288
ds_read_b128 v[132:135], v4 offset:13312
s_waitcnt lgkmcnt(2)
v_mfma_f32_16x16x32_bf16 v[100:103], v[48:51], v[136:139], v[100:103]
v_mfma_f32_16x16x32_bf16 v[104:107], v[48:51], v[140:143], v[104:107]
ds_read_b128 v[136:139], v4 offset:14336
ds_read_b128 v[140:143], v4 offset:15360
s_waitcnt lgkmcnt(2)
v_mfma_f32_16x16x32_bf16 v[100:103], v[52:55], v[128:131], v[100:103]
v_mfma_f32_16x16x32_bf16 v[104:107], v[52:55], v[132:135], v[104:107]
ds_read_b128 v[128:131], v4 offset:16384
ds_read_b128 v[132:135], v4 offset:17408
s_waitcnt lgkmcnt(2)
v_mfma_f32_16x16x32_bf16 v[100:103], v[56:59], v[136:139], v[100:103]
v_mfma_f32_16x16x32_bf16 v[104:107], v[56:59], v[140:143], v[104:107]
ds_read_b128 v[136:139], v4 offset:18432
ds_read_b128 v[140:143], v4 offset:19456
s_waitcnt lgkmcnt(2)
v_mfma_f32_16x16x32_bf16 v[100:103], v[60:63], v[128:131], v[100:103]
v_mfma_f32_16x16x32_bf16 v[104:107], v[60:63], v[132:135], v[104:107]
ds_read_b128 v[128:131], v4 offset:20480
ds_read_b128 v[132:135], v4 offset:21504
s_waitcnt lgkmcnt(2)
v_mfma_f32_16x16x32_bf16 v[100:103], v[64:67], v[136:139], v[100:103]
v_mfma_f32_16x16x32_bf16 v[104:107], v[64:67], v[140:143], v[104:107]
ds_read_b128 v[136:139], v4 offset:22528
ds_read_b128 v[140:143], v4 offset:23552
s_waitcnt lgkmcnt(2)
v_mfma_f32_16x16x32_bf16 v[100:103], v[68:71], v[128:131], v[100:103]
v_mfma_f32_16x16x32_bf16 v[104:107], v[68:71], v[132:135], v[104:107]
ds_read_b128 v[128:131], v4 offset:24576
ds_read_b128 v[132:135], v4 offset:25600
s_waitcnt lgkmcnt(2)
v_mfma_f32_16x16x32_bf16 v[100:103], v[72:75], v[136:139], v[100:103]
v_mfma_f32_16x16x32_bf16 v[104:107], v[72:75], v[140:143], v[104:107]
ds_read_b128 v[136:139], v4 offset:26624
ds_read_b128 v[140:143], v4 offset:27648
s_waitcnt lgkmcnt(2)
v_mfma_f32_16x16x32_bf16 v[100:103], v[76:79], v[128:131], v[100:103]
v_mfma_f32_16x16x32_bf16 v[104:107], v[76:79], v[132:135], v[104:107]
ds_read_b128 v[128:131], v4 offset:28672
ds_read_b128 v[132:135], v4 offset:29696
s_waitcnt lgkmcnt(2)
v_mfma_f32_16x16x32_bf16 v[100:103], v[80:83], v[136:139], v[100:103]
v_mfma_f32_16x16x32_bf16 v[104:107], v[80:83], v[140:143], v[104:107]
ds_read_b128 v[136:139], v4 offset:30720
ds_read_b128 v[140:143], v4 offset:31744
s_waitcnt lgkmcnt(2)
v_mfma_f32_16x16x32_bf16 v[100:103], v[84:87], v[128:131], v[100:103]
v_mfma_f32_16x16x32_bf16 v[104:107], v[84:87], v[132:135], v[104:107]
ds_read_b128 v[128:131], v4 offset:32768
ds_read_b128 v[132:135], v4 offset:33792
s_waitcnt lgkmcnt(2)
v_mfma_f32_16x16x32_bf16 v[100:103], v[88:91], v[136:139], v[100:103]
v_mfma_f32_16x16x32_bf16 v[104:107], v[88:91], v[140:143], v[104:107]
ds_read_b128 v[136:139], v4 offset:34816
ds_read_b128 v[140:143], v4 offset:35840
s_waitcnt lgkmcnt(2)
v_mfma_f32_16x16x32_bf16 v[100:103], v[92:95], v[128:131], v[100:103]
v_mfma_f32_16x16x32_bf16 v[104:107], v[92:95], v[132:135], v[104:107]
s_waitcnt lgkmcnt(0)
v_mfma_f32_16x16x32_bf16 v[100:103], v[96:99], v[136:139], v[100:103]
v_mfma_f32_16x16x32_bf16 v[104:107], v[96:99], v[140:143], v[104:107]
s_add_u32 s8, s20, 0x3700000
s_addc_u32 s9, s21, 0
s_mov_b32 s10, 0x240000
s_mov_b32 s11, 0x00020000
s_add_u32 s12, s20, 0x3a00000
s_addc_u32 s13, s21, 0
s_mov_b32 s14, 0x10000
s_mov_b32 s15, 0x00020000
v_lshrrev_b32 v8, 1, v3
v_lshlrev_b32 v8, 8, v8
v_lshl_add_u32 v8, v2, 4, v8
v_and_b32 v9, 1, v3
v_lshl_add_u32 v8, v9, 10, v8
s_lshr_b32 s40, s24, 1
s_mul_i32 s40, s40, 73728
s_and_b32 s41, s24, 1
s_lshl_b32 s41, s41, 11
s_add_u32 s40, s40, s41
s_lshr_b32 s41, s25, 1
s_lshl_b32 s41, s41, 12
s_add_u32 s40, s40, s41
s_and_b32 s41, s25, 1
s_lshl_b32 s41, s41, 9
s_add_u32 s40, s40, s41
s_mov_b32 s42, 0x3f803f80
v_lshlrev_b32 v116, 16, v108
v_and_b32 v117, 0xffff0000, v108
v_lshlrev_b32 v118, 16, v109
v_and_b32 v119, 0xffff0000, v109
v_fmac_f32 v116, v112, v100
v_fmac_f32 v117, v113, v101
v_fmac_f32 v118, v114, v102
v_fmac_f32 v119, v115, v103
v_cvt_pk_bf16_f32 v108, v116, v117
v_cvt_pk_bf16_f32 v109, v118, v119
v_mov_b32 v120, 0
v_mov_b32 v121, 0
v_dot2_f32_bf16 v120, v108, s42, v120
v_dot2_f32_bf16 v121, v108, v108, v121
v_dot2_f32_bf16 v120, v109, s42, v120
v_dot2_f32_bf16 v121, v109, v109, v121
v_lshlrev_b32 v116, 16, v110
v_and_b32 v117, 0xffff0000, v110
v_lshlrev_b32 v118, 16, v111
v_and_b32 v119, 0xffff0000, v111
v_fmac_f32 v116, v112, v104
v_fmac_f32 v117, v113, v105
v_fmac_f32 v118, v114, v106
v_fmac_f32 v119, v115, v107
v_cvt_pk_bf16_f32 v110, v116, v117
v_cvt_pk_bf16_f32 v111, v118, v119
v_mov_b32 v122, 0
v_mov_b32 v123, 0
v_dot2_f32_bf16 v122, v110, s42, v122
v_dot2_f32_bf16 v123, v110, v110, v123
v_dot2_f32_bf16 v122, v111, s42, v122
v_dot2_f32_bf16 v123, v111, v111, v123
v_permlane16_swap_b32 v108, v110
v_permlane16_swap_b32 v109, v111
buffer_store_dwordx4 v[108:111], v8, s[8:11], s40 offen sc0 sc1
v_mov_b32 v116, v120
s_nop 1
v_permlane16_swap_b32 v120, v116
v_add_f32 v120, v120, v116
v_mov_b32 v116, v120
s_nop 1
v_permlane32_swap_b32 v120, v116
v_add_f32 v120, v120, v116
v_mov_b32 v116, v121
s_nop 1
v_permlane16_swap_b32 v121, v116
v_add_f32 v121, v121, v116
v_mov_b32 v116, v121
s_nop 1
v_permlane32_swap_b32 v121, v116
v_add_f32 v121, v121, v116
v_mov_b32 v116, v122
s_nop 1
v_permlane16_swap_b32 v122, v116
v_add_f32 v122, v122, v116
v_mov_b32 v116, v122
s_nop 1
v_permlane32_swap_b32 v122, v116
v_add_f32 v122, v122, v116
v_mov_b32 v116, v123
s_nop 1
v_permlane16_swap_b32 v123, v116
v_add_f32 v123, v123, v116
v_mov_b32 v116, v123
s_nop 1
v_permlane32_swap_b32 v123, v116
v_add_f32 v123, v123, v116
s_lshl_b32 s26, s22, 8
v_lshlrev_b32 v9, 3, v2
v_add_u32 v9, s26, v9
ds_write_b64 v9, v[120:121] offset:36864
ds_write_b64 v9, v[122:123] offset:36992
s_waitcnt lgkmcnt(0)
s_barrier
s_cmp_lg_u32 s22, 0
s_cbranch_scc1 k3p_done
v_and_b32 v9, 31, v1
v_lshlrev_b32 v10, 3, v9
ds_read_b64 v[28:29], v10 offset:36864
ds_read_b64 v[30:31], v10 offset:37120
ds_read_b64 v[32:33], v10 offset:37376
ds_read_b64 v[34:35], v10 offset:37632
ds_read_b64 v[36:37], v10 offset:37888
ds_read_b64 v[38:39], v10 offset:38144
ds_read_b64 v[40:41], v10 offset:38400
ds_read_b64 v[42:43], v10 offset:38656
ds_read_b64 v[44:45], v10 offset:38912
s_waitcnt lgkmcnt(0)
v_add_f32 v28, v28, v30
v_add_f32 v29, v29, v31
v_add_f32 v28, v28, v32
v_add_f32 v29, v29, v33
v_add_f32 v28, v28, v34
v_add_f32 v29, v29, v35
v_add_f32 v28, v28, v36
v_add_f32 v29, v29, v37
v_add_f32 v28, v28, v38
v_add_f32 v29, v29, v39
v_add_f32 v28, v28, v40
v_add_f32 v29, v29, v41
v_add_f32 v28, v28, v42
v_add_f32 v29, v29, v43
v_add_f32 v28, v28, v44
v_add_f32 v29, v29, v45
v_lshlrev_b32 v9, 5, v9
s_lshl_b32 s26, s24, 10
s_lshl_b32 s40, s23, 3
s_add_u32 s26, s26, s40
v_cmp_gt_u32 vcc, 32, v1
s_nop 0
s_and_saveexec_b64 s[40:41], vcc
buffer_store_dwordx2 v[28:29], v9, s[12:15], s26 offen sc0 sc1
s_mov_b64 exec, s[40:41]
k3p_done:
k3_ffn:
v_and_b32 v1, 63, v0
v_and_b32 v2, 15, v1
v_lshrrev_b32 v3, 4, v1
v_lshlrev_b32 v4, 4, v1
s_and_b32 s25, s2, 7
s_lshr_b32 s26, s2, 3
s_and_b32 s23, s25, 3
s_lshl_b32 s23, s23, 1
s_and_b32 s27, s26, 1
s_add_u32 s23, s23, s27
s_lshr_b32 s24, s25, 2
s_lshl_b32 s24, s24, 4
s_lshr_b32 s26, s26, 1
s_add_u32 s24, s24, s26
s_mul_hi_u32 s26, s22, 0x55555556
s_mul_i32 s25, s26, 3
s_sub_u32 s27, s22, s25
s_waitcnt lgkmcnt(0)
s_add_u32 s8, s20, 0x3700000
s_addc_u32 s9, s21, 0
s_mov_b32 s10, 0x240000
s_mov_b32 s11, 0x00020000
s_add_u32 s12, s20, 0x1b00
s_addc_u32 s13, s21, 0
s_mov_b32 s14, 0x1200
s_mov_b32 s15, 0x00020000
s_add_u32 s16, s20, 0x300000
s_addc_u32 s17, s21, 0
s_mov_b32 s18, 0x1010000
s_mov_b32 s19, 0x00020000
s_add_u32 s44, s20, 0x2200000
s_addc_u32 s45, s21, 0
s_mov_b32 s46, 0x1200000
s_mov_b32 s47, 0x00020000
s_add_u32 s48, s20, 0x3a00000
s_addc_u32 s49, s21, 0
s_mov_b32 s50, 0x10000
s_mov_b32 s51, 0x00020000
s_mul_i32 s28, s27, 768
buffer_load_dwordx4 v[32:35], v4, s[12:15], s28 offen
s_add_u32 s28, s28, 2304
buffer_load_dwordx4 v[36:39], v4, s[12:15], s28 offen
s_mul_i32 s40, s23, 1327104
s_mul_i32 s29, s22, 110592
s_add_u32 s40, s40, s29
s_mul_i32 s41, s23, 663552
s_mul_i32 s29, s22, 55296
s_add_u32 s41, s41, s29
s_add_u32 s41, s41, 0xb00000
v_add_u32 v7, 4096, v4
s_lshl_b32 s30, s22, 11
s_add_u32 s30, s30, 73728
v_add_u32 v6, s30, v4
v_mov_b32 v5, 147456
v_mov_b32 v152, 0
ds_write_b32 v5, v152 offset:0
ds_write_b32 v5, v152 offset:4
ds_write_b32 v5, v152 offset:8
ds_write_b32 v5, v152 offset:12
ds_write_b32 v5, v152 offset:16
ds_write_b32 v5, v152 offset:20
ds_write_b32 v5, v152 offset:24
ds_write_b32 v5, v152 offset:28
ds_write_b32 v5, v152 offset:32
ds_write_b32 v5, v152 offset:36
ds_write_b32 v5, v152 offset:40
ds_write_b32 v5, v152 offset:44
ds_write_b32 v5, v152 offset:48
s_waitcnt vmcnt(0)
ds_write_b128 v6, v[32:35]
ds_write_b128 v6, v[36:39] offset:1024
s_barrier
s_mov_b32 s57, 20000
k5_in_retry:
s_lshl_b32 s28, s24, 6
s_lshl_b32 s29, s26, 4
s_add_u32 s28, s28, s29
s_lshl_b32 s28, s28, 5
v_lshlrev_b32 v5, 5, v2
buffer_load_dwordx4 v[40:43], v5, s[48:51], s28 offen sc1
buffer_load_dwordx4 v[44:47], v5, s[48:51], s28 offen offset:16 sc1
s_mul_i32 s28, s24, 73728
s_mul_i32 s29, s27, 24576
s_add_u32 s28, s28, s29
s_lshl_b32 s29, s26, 10
s_add_u32 s28, s28, s29
buffer_load_dwordx4 v[8:11], v4, s[8:11], s28 offen sc1
s_add_u32 s28, s28, 4096
buffer_load_dwordx4 v[12:15], v4, s[8:11], s28 offen sc1
s_add_u32 s28, s28, 4096
buffer_load_dwordx4 v[16:19], v4, s[8:11], s28 offen sc1
s_add_u32 s28, s28, 4096
buffer_load_dwordx4 v[20:23], v4, s[8:11], s28 offen sc1
s_add_u32 s28, s28, 4096
buffer_load_dwordx4 v[24:27], v4, s[8:11], s28 offen sc1
s_add_u32 s28, s28, 4096
buffer_load_dwordx4 v[28:31], v4, s[8:11], s28 offen sc1
s_waitcnt vmcnt(0)
v_max3_u32 v152, v8, v9, v10
v_max3_u32 v152, v11, v12, v152
v_max3_u32 v152, v13, v14, v152
v_max3_u32 v152, v15, v16, v152
v_max3_u32 v152, v17, v18, v152
v_max3_u32 v152, v19, v20, v152
v_max3_u32 v152, v21, v22, v152
v_max3_u32 v152, v23, v24, v152
v_max3_u32 v152, v25, v26, v152
v_max3_u32 v152, v27, v28, v152
v_max3_u32 v152, v29, v30, v152
v_max3_u32 v152, v31, v40, v152
v_max3_u32 v152, v41, v42, v152
v_max3_u32 v152, v43, v44, v152
v_max3_u32 v152, v45, v46, v152
v_max_u32 v152, v47, v152
v_cmp_eq_u32 vcc, -1, v152
s_sub_u32 s57, s57, 1
s_cmp_eq_u32 s57, 0
s_cbranch_scc1 k5_in_got
s_cmp_lg_u64 vcc, 0
s_cbranch_scc1 k5_in_retry
k5_in_got:
v_add_f32 v40, v40, v42
v_add_f32 v41, v41, v43
v_add_f32 v44, v44, v46
v_add_f32 v45, v45, v47
v_add_f32 v40, v40, v44
v_add_f32 v41, v41, v45
v_mul_f32 v40, 0x3ae38e39, v40
v_mul_f32 v41, 0x3ae38e39, v41
v_fma_f32 v41, -v40, v40, v41
v_max_f32 v41, 0, v41
v_add_f32 v41, 0x3727c5ac, v41
v_rsq_f32 v48, v41
s_nop 0
v_mul_f32 v50, v40, v48
v_sub_f32 v50, 0, v50
v_mov_b32 v49, v48
v_mov_b32 v51, v50
v_lshlrev_b32 v5, 5, v3
v_add_u32 v5, s30, v5
s_mul_i32 s28, s27, 24576
s_lshl_b32 s29, s26, 10
s_add_u32 s28, s28, s29
v_add_u32 v6, s28, v4
s_waitcnt lgkmcnt(0)
ds_read_b128 v[64:67], v5 offset:0
ds_read_b128 v[68:71], v5 offset:16
ds_read_b128 v[56:59], v5 offset:1024
ds_read_b128 v[60:63], v5 offset:1040
ds_read_b128 v[80:83], v5 offset:128
ds_read_b128 v[84:87], v5 offset:144
ds_read_b128 v[72:75], v5 offset:1152
ds_read_b128 v[76:79], v5 offset:1168
s_waitcnt lgkmcnt(4)
v_lshlrev_b32 v88, 16, v8
v_and_b32 v89, 0xffff0000, v8
v_lshlrev_b32 v90, 16, v9
v_and_b32 v91, 0xffff0000, v9
v_lshlrev_b32 v92, 16, v10
v_and_b32 v93, 0xffff0000, v10
v_lshlrev_b32 v94, 16, v11
v_and_b32 v95, 0xffff0000, v11
v_pk_fma_f32 v[88:89], v[88:89], v[48:49], v[50:51]
v_pk_fma_f32 v[90:91], v[90:91], v[48:49], v[50:51]
v_pk_fma_f32 v[92:93], v[92:93], v[48:49], v[50:51]
v_pk_fma_f32 v[94:95], v[94:95], v[48:49], v[50:51]
v_pk_fma_f32 v[88:89], v[88:89], v[56:57], v[64:65]
v_pk_fma_f32 v[90:91], v[90:91], v[58:59], v[66:67]
v_pk_fma_f32 v[92:93], v[92:93], v[60:61], v[68:69]
v_pk_fma_f32 v[94:95], v[94:95], v[62:63], v[70:71]
v_cvt_pk_bf16_f32 v96, v88, v89
v_cvt_pk_bf16_f32 v97, v90, v91
v_cvt_pk_bf16_f32 v98, v92, v93
v_cvt_pk_bf16_f32 v99, v94, v95
ds_write_b128 v6, v[96:99] offset:0
buffer_load_dwordx4 v[104:107], v4, s[16:19], s40 offen offset:0 sc1
buffer_load_dwordx4 v[108:111], v4, s[16:19], s40 offen offset:1024 sc1
ds_read_b128 v[64:67], v5 offset:256
ds_read_b128 v[68:71], v5 offset:272
ds_read_b128 v[56:59], v5 offset:1280
ds_read_b128 v[60:63], v5 offset:1296
s_waitcnt lgkmcnt(4)
v_lshlrev_b32 v88, 16, v12
v_and_b32 v89, 0xffff0000, v12
v_lshlrev_b32 v90, 16, v13
v_and_b32 v91, 0xffff0000, v13
v_lshlrev_b32 v92, 16, v14
v_and_b32 v93, 0xffff0000, v14
v_lshlrev_b32 v94, 16, v15
v_and_b32 v95, 0xffff0000, v15
v_pk_fma_f32 v[88:89], v[88:89], v[48:49], v[50:51]
v_pk_fma_f32 v[90:91], v[90:91], v[48:49], v[50:51]
v_pk_fma_f32 v[92:93], v[92:93], v[48:49], v[50:51]
v_pk_fma_f32 v[94:95], v[94:95], v[48:49], v[50:51]
v_pk_fma_f32 v[88:89], v[88:89], v[72:73], v[80:81]
v_pk_fma_f32 v[90:91], v[90:91], v[74:75], v[82:83]
v_pk_fma_f32 v[92:93], v[92:93], v[76:77], v[84:85]
v_pk_fma_f32 v[94:95], v[94:95], v[78:79], v[86:87]
v_cvt_pk_bf16_f32 v100, v88, v89
v_cvt_pk_bf16_f32 v101, v90, v91
v_cvt_pk_bf16_f32 v102, v92, v93
v_cvt_pk_bf16_f32 v103, v94, v95
ds_write_b128 v6, v[100:103] offset:4096
buffer_load_dwordx4 v[112:115], v4, s[16:19], s40 offen offset:2048 sc1
buffer_load_dwordx4 v[116:119], v4, s[16:19], s40 offen offset:3072 sc1
ds_read_b128 v[80:83], v5 offset:384
ds_read_b128 v[84:87], v5 offset:400
ds_read_b128 v[72:75], v5 offset:1408
ds_read_b128 v[76:79], v5 offset:1424
s_waitcnt lgkmcnt(4)
v_lshlrev_b32 v88, 16, v16
v_and_b32 v89, 0xffff0000, v16
v_lshlrev_b32 v90, 16, v17
v_and_b32 v91, 0xffff0000, v17
v_lshlrev_b32 v92, 16, v18
v_and_b32 v93, 0xffff0000, v18
v_lshlrev_b32 v94, 16, v19
v_and_b32 v95, 0xffff0000, v19
v_pk_fma_f32 v[88:89], v[88:89], v[48:49], v[50:51]
v_pk_fma_f32 v[90:91], v[90:91], v[48:49], v[50:51]
v_pk_fma_f32 v[92:93], v[92:93], v[48:49], v[50:51]
v_pk_fma_f32 v[94:95], v[94:95], v[48:49], v[50:51]
v_pk_fma_f32 v[88:89], v[88:89], v[56:57], v[64:65]
v_pk_fma_f32 v[90:91], v[90:91], v[58:59], v[66:67]
v_pk_fma_f32 v[92:93], v[92:93], v[60:61], v[68:69]
v_pk_fma_f32 v[94:95], v[94:95], v[62:63], v[70:71]
v_cvt_pk_bf16_f32 v96, v88, v89
v_cvt_pk_bf16_f32 v97, v90, v91
v_cvt_pk_bf16_f32 v98, v92, v93
v_cvt_pk_bf16_f32 v99, v94, v95
ds_write_b128 v6, v[96:99] offset:8192
buffer_load_dwordx4 v[120:123], v7, s[16:19], s40 offen offset:0 sc1
buffer_load_dwordx4 v[124:127], v7, s[16:19], s40 offen offset:1024 sc1
s_add_u32 s40, s40, 6144
ds_read_b128 v[64:67], v5 offset:512
ds_read_b128 v[68:71], v5 offset:528
ds_read_b128 v[56:59], v5 offset:1536
ds_read_b128 v[60:63], v5 offset:1552
s_waitcnt lgkmcnt(4)
v_lshlrev_b32 v88, 16, v20
v_and_b32 v89, 0xffff0000, v20
v_lshlrev_b32 v90, 16, v21
v_and_b32 v91, 0xffff0000, v21
v_lshlrev_b32 v92, 16, v22
v_and_b32 v93, 0xffff0000, v22
v_lshlrev_b32 v94, 16, v23
v_and_b32 v95, 0xffff0000, v23
v_pk_fma_f32 v[88:89], v[88:89], v[48:49], v[50:51]
v_pk_fma_f32 v[90:91], v[90:91], v[48:49], v[50:51]
v_pk_fma_f32 v[92:93], v[92:93], v[48:49], v[50:51]
v_pk_fma_f32 v[94:95], v[94:95], v[48:49], v[50:51]
v_pk_fma_f32 v[88:89], v[88:89], v[72:73], v[80:81]
v_pk_fma_f32 v[90:91], v[90:91], v[74:75], v[82:83]
v_pk_fma_f32 v[92:93], v[92:93], v[76:77], v[84:85]
v_pk_fma_f32 v[94:95], v[94:95], v[78:79], v[86:87]
v_cvt_pk_bf16_f32 v100, v88, v89
v_cvt_pk_bf16_f32 v101, v90, v91
v_cvt_pk_bf16_f32 v102, v92, v93
v_cvt_pk_bf16_f32 v103, v94, v95
ds_write_b128 v6, v[100:103] offset:12288
buffer_load_dwordx4 v[128:131], v4, s[16:19], s40 offen offset:0 sc1
buffer_load_dwordx4 v[132:135], v4, s[16:19], s40 offen offset:1024 sc1
ds_read_b128 v[80:83], v5 offset:640
ds_read_b128 v[84:87], v5 offset:656
ds_read_b128 v[72:75], v5 offset:1664
ds_read_b128 v[76:79], v5 offset:1680
s_waitcnt lgkmcnt(4)
v_lshlrev_b32 v88, 16, v24
v_and_b32 v89, 0xffff0000, v24
v_lshlrev_b32 v90, 16, v25
v_and_b32 v91, 0xffff0000, v25
v_lshlrev_b32 v92, 16, v26
v_and_b32 v93, 0xffff0000, v26
v_lshlrev_b32 v94, 16, v27
v_and_b32 v95, 0xffff0000, v27
v_pk_fma_f32 v[88:89], v[88:89], v[48:49], v[50:51]
v_pk_fma_f32 v[90:91], v[90:91], v[48:49], v[50:51]
v_pk_fma_f32 v[92:93], v[92:93], v[48:49], v[50:51]
v_pk_fma_f32 v[94:95], v[94:95], v[48:49], v[50:51]
v_pk_fma_f32 v[88:89], v[88:89], v[56:57], v[64:65]
v_pk_fma_f32 v[90:91], v[90:91], v[58:59], v[66:67]
v_pk_fma_f32 v[92:93], v[92:93], v[60:61], v[68:69]
v_pk_fma_f32 v[94:95], v[94:95], v[62:63], v[70:71]
v_cvt_pk_bf16_f32 v96, v88, v89
v_cvt_pk_bf16_f32 v97, v90, v91
v_cvt_pk_bf16_f32 v98, v92, v93
v_cvt_pk_bf16_f32 v99, v94, v95
ds_write_b128 v6, v[96:99] offset:16384
buffer_load_dwordx4 v[136:139], v4, s[16:19], s40 offen offset:2048 sc1
buffer_load_dwordx4 v[140:143], v4, s[16:19], s40 offen offset:3072 sc1
s_waitcnt lgkmcnt(0)
v_lshlrev_b32 v88, 16, v28
v_and_b32 v89, 0xffff0000, v28
v_lshlrev_b32 v90, 16, v29
v_and_b32 v91, 0xffff0000, v29
v_lshlrev_b32 v92, 16, v30
v_and_b32 v93, 0xffff0000, v30
v_lshlrev_b32 v94, 16, v31
v_and_b32 v95, 0xffff0000, v31
v_pk_fma_f32 v[88:89], v[88:89], v[48:49], v[50:51]
v_pk_fma_f32 v[90:91], v[90:91], v[48:49], v[50:51]
v_pk_fma_f32 v[92:93], v[92:93], v[48:49], v[50:51]
v_pk_fma_f32 v[94:95], v[94:95], v[48:49], v[50:51]
v_pk_fma_f32 v[88:89], v[88:89], v[72:73], v[80:81]
v_pk_fma_f32 v[90:91], v[90:91], v[74:75], v[82:83]
v_pk_fma_f32 v[92:93], v[92:93], v[76:77], v[84:85]
v_pk_fma_f32 v[94:95], v[94:95], v[78:79], v[86:87]
v_cvt_pk_bf16_f32 v100, v88, v89
v_cvt_pk_bf16_f32 v101, v90, v91
v_cvt_pk_bf16_f32 v102, v92, v93
v_cvt_pk_bf16_f32 v103, v94, v95
ds_write_b128 v6, v[100:103] offset:20480
buffer_load_dwordx4 v[144:147], v7, s[16:19], s40 offen offset:0 sc1
buffer_load_dwordx4 v[148:151], v7, s[16:19], s40 offen offset:1024 sc1
s_add_u32 s40, s40, 6144
s_waitcnt lgkmcnt(0)
s_barrier
v_mov_b32 v5, v4
ds_read_b128 v[152:155], v5 offset:0
ds_read_b128 v[156:159], v5 offset:1024
ds_read_b128 v[160:163], v5 offset:2048
ds_read_b128 v[164:167], v5 offset:3072
s_waitcnt vmcnt(6) lgkmcnt(3)
v_mfma_f32_16x16x32_bf16 v[8:11], v[104:107], v[152:155], 0
v_mfma_f32_16x16x32_bf16 v[24:27], v[108:111], v[152:155], 0
v_mfma_f32_16x16x32_bf16 v[40:43], v[112:115], v[152:155], 0
v_mfma_f32_16x16x32_bf16 v[56:59], v[116:119], v[152:155], 0
v_mfma_f32_16x16x32_bf16 v[72:75], v[120:123], v[152:155], 0
v_mfma_f32_16x16x32_bf16 v[88:91], v[124:127], v[152:155], 0
ds_read_b128 v[152:155], v5 offset:4096
s_waitcnt lgkmcnt(3)
v_mfma_f32_16x16x32_bf16 v[12:15], v[104:107], v[156:159], 0
v_mfma_f32_16x16x32_bf16 v[28:31], v[108:111], v[156:159], 0
v_mfma_f32_16x16x32_bf16 v[44:47], v[112:115], v[156:159], 0
v_mfma_f32_16x16x32_bf16 v[60:63], v[116:119], v[156:159], 0
v_mfma_f32_16x16x32_bf16 v[76:79], v[120:123], v[156:159], 0
v_mfma_f32_16x16x32_bf16 v[92:95], v[124:127], v[156:159], 0
ds_read_b128 v[156:159], v5 offset:5120
s_waitcnt lgkmcnt(3)
v_mfma_f32_16x16x32_bf16 v[16:19], v[104:107], v[160:163], 0
v_mfma_f32_16x16x32_bf16 v[32:35], v[108:111], v[160:163], 0
v_mfma_f32_16x16x32_bf16 v[48:51], v[112:115], v[160:163], 0
v_mfma_f32_16x16x32_bf16 v[64:67], v[116:119], v[160:163], 0
v_mfma_f32_16x16x32_bf16 v[80:83], v[120:123], v[160:163], 0
v_mfma_f32_16x16x32_bf16 v[96:99], v[124:127], v[160:163], 0
ds_read_b128 v[160:163], v5 offset:6144
s_waitcnt lgkmcnt(3)
v_mfma_f32_16x16x32_bf16 v[20:23], v[104:107], v[164:167], 0
buffer_load_dwordx4 v[104:107], v4, s[16:19], s40 offen offset:0 sc1
v_mfma_f32_16x16x32_bf16 v[36:39], v[108:111], v[164:167], 0
buffer_load_dwordx4 v[108:111], v4, s[16:19], s40 offen offset:1024 sc1
v_mfma_f32_16x16x32_bf16 v[52:55], v[112:115], v[164:167], 0
buffer_load_dwordx4 v[112:115], v4, s[16:19], s40 offen offset:2048 sc1
v_mfma_f32_16x16x32_bf16 v[68:71], v[116:119], v[164:167], 0
buffer_load_dwordx4 v[116:119], v4, s[16:19], s40 offen offset:3072 sc1
v_mfma_f32_16x16x32_bf16 v[84:87], v[120:123], v[164:167], 0
buffer_load_dwordx4 v[120:123], v7, s[16:19], s40 offen offset:0 sc1
v_mfma_f32_16x16x32_bf16 v[100:103], v[124:127], v[164:167], 0
buffer_load_dwordx4 v[124:127], v7, s[16:19], s40 offen offset:1024 sc1
ds_read_b128 v[164:167], v5 offset:7168
s_add_u32 s40, s40, 6144
v_add_u32 v5, 8192, v5
s_mov_b32 s42, 7
k5_loop1:
s_waitcnt vmcnt(6) lgkmcnt(3)
v_mfma_f32_16x16x32_bf16 v[8:11], v[128:131], v[152:155], v[8:11]
v_mfma_f32_16x16x32_bf16 v[24:27], v[132:135], v[152:155], v[24:27]
v_mfma_f32_16x16x32_bf16 v[40:43], v[136:139], v[152:155], v[40:43]
v_mfma_f32_16x16x32_bf16 v[56:59], v[140:143], v[152:155], v[56:59]
v_mfma_f32_16x16x32_bf16 v[72:75], v[144:147], v[152:155], v[72:75]
v_mfma_f32_16x16x32_bf16 v[88:91], v[148:151], v[152:155], v[88:91]
ds_read_b128 v[152:155], v5 offset:0
s_waitcnt lgkmcnt(3)
v_mfma_f32_16x16x32_bf16 v[12:15], v[128:131], v[156:159], v[12:15]
v_mfma_f32_16x16x32_bf16 v[28:31], v[132:135], v[156:159], v[28:31]
v_mfma_f32_16x16x32_bf16 v[44:47], v[136:139], v[156:159], v[44:47]
v_mfma_f32_16x16x32_bf16 v[60:63], v[140:143], v[156:159], v[60:63]
v_mfma_f32_16x16x32_bf16 v[76:79], v[144:147], v[156:159], v[76:79]
v_mfma_f32_16x16x32_bf16 v[92:95], v[148:151], v[156:159], v[92:95]
ds_read_b128 v[156:159], v5 offset:1024
s_waitcnt lgkmcnt(3)
v_mfma_f32_16x16x32_bf16 v[16:19], v[128:131], v[160:163], v[16:19]
v_mfma_f32_16x16x32_bf16 v[32:35], v[132:135], v[160:163], v[32:35]
v_mfma_f32_16x16x32_bf16 v[48:51], v[136:139], v[160:163], v[48:51]
v_mfma_f32_16x16x32_bf16 v[64:67], v[140:143], v[160:163], v[64:67]
v_mfma_f32_16x16x32_bf16 v[80:83], v[144:147], v[160:163], v[80:83]
v_mfma_f32_16x16x32_bf16 v[96:99], v[148:151], v[160:163], v[96:99]
ds_read_b128 v[160:163], v5 offset:2048
s_waitcnt lgkmcnt(3)
v_mfma_f32_16x16x32_bf16 v[20:23], v[128:131], v[164:167], v[20:23]
buffer_load_dwordx4 v[128:131], v4, s[16:19], s40 offen offset:0 sc1
v_mfma_f32_16x16x32_bf16 v[36:39], v[132:135], v[164:167], v[36:39]
buffer_load_dwordx4 v[132:135], v4, s[16:19], s40 offen offset:1024 sc1
v_mfma_f32_16x16x32_bf16 v[52:55], v[136:139], v[164:167], v[52:55]
buffer_load_dwordx4 v[136:139], v4, s[16:19], s40 offen offset:2048 sc1
v_mfma_f32_16x16x32_bf16 v[68:71], v[140:143], v[164:167], v[68:71]
buffer_load_dwordx4 v[140:143], v4, s[16:19], s40 offen offset:3072 sc1
v_mfma_f32_16x16x32_bf16 v[84:87], v[144:147], v[164:167], v[84:87]
buffer_load_dwordx4 v[144:147], v7, s[16:19], s40 offen offset:0 sc1
v_mfma_f32_16x16x32_bf16 v[100:103], v[148:151], v[164:167], v[100:103]
buffer_load_dwordx4 v[148:151], v7, s[16:19], s40 offen offset:1024 sc1
ds_read_b128 v[164:167], v5 offset:3072
s_add_u32 s40, s40, 6144
s_waitcnt vmcnt(6) lgkmcnt(3)
v_mfma_f32_16x16x32_bf16 v[8:11], v[104:107], v[152:155], v[8:11]
v_mfma_f32_16x16x32_bf16 v[24:27], v[108:111], v[152:155], v[24:27]
v_mfma_f32_16x16x32_bf16 v[40:43], v[112:115], v[152:155], v[40:43]
v_mfma_f32_16x16x32_bf16 v[56:59], v[116:119], v[152:155], v[56:59]
v_mfma_f32_16x16x32_bf16 v[72:75], v[120:123], v[152:155], v[72:75]
v_mfma_f32_16x16x32_bf16 v[88:91], v[124:127], v[152:155], v[88:91]
ds_read_b128 v[152:155], v5 offset:4096
s_waitcnt lgkmcnt(3)
v_mfma_f32_16x16x32_bf16 v[12:15], v[104:107], v[156:159], v[12:15]
v_mfma_f32_16x16x32_bf16 v[28:31], v[108:111], v[156:159], v[28:31]
v_mfma_f32_16x16x32_bf16 v[44:47], v[112:115], v[156:159], v[44:47]
v_mfma_f32_16x16x32_bf16 v[60:63], v[116:119], v[156:159], v[60:63]
v_mfma_f32_16x16x32_bf16 v[76:79], v[120:123], v[156:159], v[76:79]
v_mfma_f32_16x16x32_bf16 v[92:95], v[124:127], v[156:159], v[92:95]
ds_read_b128 v[156:159], v5 offset:5120
s_waitcnt lgkmcnt(3)
v_mfma_f32_16x16x32_bf16 v[16:19], v[104:107], v[160:163], v[16:19]
v_mfma_f32_16x16x32_bf16 v[32:35], v[108:111], v[160:163], v[32:35]
v_mfma_f32_16x16x32_bf16 v[48:51], v[112:115], v[160:163], v[48:51]
v_mfma_f32_16x16x32_bf16 v[64:67], v[116:119], v[160:163], v[64:67]
v_mfma_f32_16x16x32_bf16 v[80:83], v[120:123], v[160:163], v[80:83]
v_mfma_f32_16x16x32_bf16 v[96:99], v[124:127], v[160:163], v[96:99]
ds_read_b128 v[160:163], v5 offset:6144
s_waitcnt lgkmcnt(3)
v_mfma_f32_16x16x32_bf16 v[20:23], v[104:107], v[164:167], v[20:23]
buffer_load_dwordx4 v[104:107], v4, s[16:19], s40 offen offset:0 sc1
v_mfma_f32_16x16x32_bf16 v[36:39], v[108:111], v[164:167], v[36:39]
buffer_load_dwordx4 v[108:111], v4, s[16:19], s40 offen offset:1024 sc1
v_mfma_f32_16x16x32_bf16 v[52:55], v[112:115], v[164:167], v[52:55]
buffer_load_dwordx4 v[112:115], v4, s[16:19], s40 offen offset:2048 sc1
v_mfma_f32_16x16x32_bf16 v[68:71], v[116:119], v[164:167], v[68:71]
buffer_load_dwordx4 v[116:119], v4, s[16:19], s40 offen offset:3072 sc1
v_mfma_f32_16x16x32_bf16 v[84:87], v[120:123], v[164:167], v[84:87]
buffer_load_dwordx4 v[120:123], v7, s[16:19], s40 offen offset:0 sc1
v_mfma_f32_16x16x32_bf16 v[100:103], v[124:127], v[164:167], v[100:103]
buffer_load_dwordx4 v[124:127], v7, s[16:19], s40 offen offset:1024 sc1
ds_read_b128 v[164:167], v5 offset:7168
s_add_u32 s40, s40, 6144
v_add_u32 v5, 8192, v5
s_sub_u32 s42, s42, 1
s_cmp_lg_u32 s42, 0
s_cbranch_scc1 k5_loop1
s_waitcnt vmcnt(6) lgkmcnt(3)
v_mfma_f32_16x16x32_bf16 v[8:11], v[128:131], v[152:155], v[8:11]
v_mfma_f32_16x16x32_bf16 v[24:27], v[132:135], v[152:155], v[24:27]
v_mfma_f32_16x16x32_bf16 v[40:43], v[136:139], v[152:155], v[40:43]
v_mfma_f32_16x16x32_bf16 v[56:59], v[140:143], v[152:155], v[56:59]
v_mfma_f32_16x16x32_bf16 v[72:75], v[144:147], v[152:155], v[72:75]
v_mfma_f32_16x16x32_bf16 v[88:91], v[148:151], v[152:155], v[88:91]
ds_read_b128 v[152:155], v5 offset:0
s_waitcnt lgkmcnt(3)
v_mfma_f32_16x16x32_bf16 v[12:15], v[128:131], v[156:159], v[12:15]
v_mfma_f32_16x16x32_bf16 v[28:31], v[132:135], v[156:159], v[28:31]
v_mfma_f32_16x16x32_bf16 v[44:47], v[136:139], v[156:159], v[44:47]
v_mfma_f32_16x16x32_bf16 v[60:63], v[140:143], v[156:159], v[60:63]
v_mfma_f32_16x16x32_bf16 v[76:79], v[144:147], v[156:159], v[76:79]
v_mfma_f32_16x16x32_bf16 v[92:95], v[148:151], v[156:159], v[92:95]
ds_read_b128 v[156:159], v5 offset:1024
s_waitcnt lgkmcnt(3)
v_mfma_f32_16x16x32_bf16 v[16:19], v[128:131], v[160:163], v[16:19]
v_mfma_f32_16x16x32_bf16 v[32:35], v[132:135], v[160:163], v[32:35]
v_mfma_f32_16x16x32_bf16 v[48:51], v[136:139], v[160:163], v[48:51]
v_mfma_f32_16x16x32_bf16 v[64:67], v[140:143], v[160:163], v[64:67]
v_mfma_f32_16x16x32_bf16 v[80:83], v[144:147], v[160:163], v[80:83]
v_mfma_f32_16x16x32_bf16 v[96:99], v[148:151], v[160:163], v[96:99]
ds_read_b128 v[160:163], v5 offset:2048
s_waitcnt lgkmcnt(3)
v_mfma_f32_16x16x32_bf16 v[20:23], v[128:131], v[164:167], v[20:23]
buffer_load_dwordx4 v[128:131], v4, s[16:19], s40 offen offset:0 sc1
v_mfma_f32_16x16x32_bf16 v[36:39], v[132:135], v[164:167], v[36:39]
buffer_load_dwordx4 v[132:135], v4, s[16:19], s40 offen offset:1024 sc1
v_mfma_f32_16x16x32_bf16 v[52:55], v[136:139], v[164:167], v[52:55]
buffer_load_dwordx4 v[136:139], v4, s[16:19], s40 offen offset:2048 sc1
v_mfma_f32_16x16x32_bf16 v[68:71], v[140:143], v[164:167], v[68:71]
buffer_load_dwordx4 v[140:143], v4, s[16:19], s40 offen offset:3072 sc1
v_mfma_f32_16x16x32_bf16 v[84:87], v[144:147], v[164:167], v[84:87]
buffer_load_dwordx4 v[144:147], v7, s[16:19], s40 offen offset:0 sc1
v_mfma_f32_16x16x32_bf16 v[100:103], v[148:151], v[164:167], v[100:103]
buffer_load_dwordx4 v[148:151], v7, s[16:19], s40 offen offset:1024 sc1
ds_read_b128 v[164:167], v5 offset:3072
s_add_u32 s40, s40, 6144
s_waitcnt vmcnt(6) lgkmcnt(3)
v_mfma_f32_16x16x32_bf16 v[8:11], v[104:107], v[152:155], v[8:11]
v_mfma_f32_16x16x32_bf16 v[24:27], v[108:111], v[152:155], v[24:27]
v_mfma_f32_16x16x32_bf16 v[40:43], v[112:115], v[152:155], v[40:43]
v_mfma_f32_16x16x32_bf16 v[56:59], v[116:119], v[152:155], v[56:59]
v_mfma_f32_16x16x32_bf16 v[72:75], v[120:123], v[152:155], v[72:75]
v_mfma_f32_16x16x32_bf16 v[88:91], v[124:127], v[152:155], v[88:91]
ds_read_b128 v[152:155], v5 offset:4096
s_waitcnt lgkmcnt(3)
v_mfma_f32_16x16x32_bf16 v[12:15], v[104:107], v[156:159], v[12:15]
v_mfma_f32_16x16x32_bf16 v[28:31], v[108:111], v[156:159], v[28:31]
v_mfma_f32_16x16x32_bf16 v[44:47], v[112:115], v[156:159], v[44:47]
v_mfma_f32_16x16x32_bf16 v[60:63], v[116:119], v[156:159], v[60:63]
v_mfma_f32_16x16x32_bf16 v[76:79], v[120:123], v[156:159], v[76:79]
v_mfma_f32_16x16x32_bf16 v[92:95], v[124:127], v[156:159], v[92:95]
ds_read_b128 v[156:159], v5 offset:5120
s_waitcnt lgkmcnt(3)
v_mfma_f32_16x16x32_bf16 v[16:19], v[104:107], v[160:163], v[16:19]
v_mfma_f32_16x16x32_bf16 v[32:35], v[108:111], v[160:163], v[32:35]
v_mfma_f32_16x16x32_bf16 v[48:51], v[112:115], v[160:163], v[48:51]
v_mfma_f32_16x16x32_bf16 v[64:67], v[116:119], v[160:163], v[64:67]
v_mfma_f32_16x16x32_bf16 v[80:83], v[120:123], v[160:163], v[80:83]
v_mfma_f32_16x16x32_bf16 v[96:99], v[124:127], v[160:163], v[96:99]
ds_read_b128 v[160:163], v5 offset:6144
s_waitcnt lgkmcnt(3)
v_mfma_f32_16x16x32_bf16 v[20:23], v[104:107], v[164:167], v[20:23]
buffer_load_dwordx4 v[104:107], v4, s[16:19], s41 offen offset:0 sc1
v_mfma_f32_16x16x32_bf16 v[36:39], v[108:111], v[164:167], v[36:39]
buffer_load_dwordx4 v[108:111], v4, s[16:19], s41 offen offset:1024 sc1
v_mfma_f32_16x16x32_bf16 v[52:55], v[112:115], v[164:167], v[52:55]
buffer_load_dwordx4 v[112:115], v4, s[16:19], s41 offen offset:2048 sc1
v_mfma_f32_16x16x32_bf16 v[68:71], v[116:119], v[164:167], v[68:71]
buffer_load_dwordx4 v[116:119], v4, s[16:19], s41 offen offset:3072 sc1
v_mfma_f32_16x16x32_bf16 v[84:87], v[120:123], v[164:167], v[84:87]
buffer_load_dwordx4 v[120:123], v7, s[16:19], s41 offen offset:0 sc1
v_mfma_f32_16x16x32_bf16 v[100:103], v[124:127], v[164:167], v[100:103]
buffer_load_dwordx4 v[124:127], v7, s[16:19], s41 offen offset:1024 sc1
ds_read_b128 v[164:167], v5 offset:7168
s_add_u32 s41, s41, 6144
s_waitcnt vmcnt(6) lgkmcnt(3)
v_mfma_f32_16x16x32_bf16 v[8:11], v[128:131], v[152:155], v[8:11]
v_mfma_f32_16x16x32_bf16 v[24:27], v[132:135], v[152:155], v[24:27]
v_mfma_f32_16x16x32_bf16 v[40:43], v[136:139], v[152:155], v[40:43]
v_mfma_f32_16x16x32_bf16 v[56:59], v[140:143], v[152:155], v[56:59]
v_mfma_f32_16x16x32_bf16 v[72:75], v[144:147], v[152:155], v[72:75]
v_mfma_f32_16x16x32_bf16 v[88:91], v[148:151], v[152:155], v[88:91]
s_waitcnt lgkmcnt(2)
v_mfma_f32_16x16x32_bf16 v[12:15], v[128:131], v[156:159], v[12:15]
v_mfma_f32_16x16x32_bf16 v[28:31], v[132:135], v[156:159], v[28:31]
v_mfma_f32_16x16x32_bf16 v[44:47], v[136:139], v[156:159], v[44:47]
v_mfma_f32_16x16x32_bf16 v[60:63], v[140:143], v[156:159], v[60:63]
v_mfma_f32_16x16x32_bf16 v[76:79], v[144:147], v[156:159], v[76:79]
v_mfma_f32_16x16x32_bf16 v[92:95], v[148:151], v[156:159], v[92:95]
s_waitcnt lgkmcnt(1)
v_mfma_f32_16x16x32_bf16 v[16:19], v[128:131], v[160:163], v[16:19]
v_mfma_f32_16x16x32_bf16 v[32:35], v[132:135], v[160:163], v[32:35]
v_mfma_f32_16x16x32_bf16 v[48:51], v[136:139], v[160:163], v[48:51]
v_mfma_f32_16x16x32_bf16 v[64:67], v[140:143], v[160:163], v[64:67]
v_mfma_f32_16x16x32_bf16 v[80:83], v[144:147], v[160:163], v[80:83]
v_mfma_f32_16x16x32_bf16 v[96:99], v[148:151], v[160:163], v[96:99]
s_waitcnt lgkmcnt(0)
v_mfma_f32_16x16x32_bf16 v[20:23], v[128:131], v[164:167], v[20:23]
buffer_load_dwordx4 v[128:131], v4, s[16:19], s41 offen offset:0 sc1
v_mfma_f32_16x16x32_bf16 v[36:39], v[132:135], v[164:167], v[36:39]
buffer_load_dwordx4 v[132:135], v4, s[16:19], s41 offen offset:1024 sc1
v_mfma_f32_16x16x32_bf16 v[52:55], v[136:139], v[164:167], v[52:55]
buffer_load_dwordx4 v[136:139], v4, s[16:19], s41 offen offset:2048 sc1
v_mfma_f32_16x16x32_bf16 v[68:71], v[140:143], v[164:167], v[68:71]
buffer_load_dwordx4 v[140:143], v4, s[16:19], s41 offen offset:3072 sc1
v_mfma_f32_16x16x32_bf16 v[84:87], v[144:147], v[164:167], v[84:87]
buffer_load_dwordx4 v[144:147], v7, s[16:19], s41 offen offset:0 sc1
v_mfma_f32_16x16x32_bf16 v[100:103], v[148:151], v[164:167], v[100:103]
buffer_load_dwordx4 v[148:151], v7, s[16:19], s41 offen offset:1024 sc1
s_add_u32 s41, s41, 6144
s_mov_b32 s56, 0xbfb8aa3b
s_mov_b32 s57, 0xbfb8aa3b
s_mov_b32 s58, 1.0
s_mov_b32 s59, 1.0
s_mul_i32 s28, s22, 3
s_add_u32 s29, s28, 0
s_lshr_b32 s25, s29, 1
s_lshl_b32 s25, s25, 12
s_and_b32 s29, s29, 1
s_lshl_b32 s29, s29, 3
s_add_u32 s25, s25, s29
s_add_u32 s25, s25, 73728
v_add_u32 v6, s25, v4
v_pk_mul_f32 v[152:153], v[8:9], s[56:57]
v_pk_mul_f32 v[154:155], v[10:11], s[56:57]
v_exp_f32 v152, v152
v_exp_f32 v153, v153
v_exp_f32 v154, v154
v_exp_f32 v155, v155
v_pk_mul_f32 v[8:9], v[8:9], v[24:25]
v_pk_mul_f32 v[10:11], v[10:11], v[26:27]
v_pk_add_f32 v[152:153], v[152:153], s[58:59]
v_pk_add_f32 v[154:155], v[154:155], s[58:59]
v_rcp_f32 v152, v152
v_rcp_f32 v153, v153
v_rcp_f32 v154, v154
v_rcp_f32 v155, v155
s_nop 0
v_pk_mul_f32 v[8:9], v[8:9], v[152:153]
v_pk_mul_f32 v[10:11], v[10:11], v[154:155]
v_cvt_pk_bf16_f32 v156, v8, v9
v_cvt_pk_bf16_f32 v157, v10, v11
ds_write_b64 v6, v[156:157] offset:0
v_pk_mul_f32 v[152:153], v[12:13], s[56:57]
v_pk_mul_f32 v[154:155], v[14:15], s[56:57]
v_exp_f32 v152, v152
v_exp_f32 v153, v153
v_exp_f32 v154, v154
v_exp_f32 v155, v155
v_pk_mul_f32 v[12:13], v[12:13], v[28:29]
v_pk_mul_f32 v[14:15], v[14:15], v[30:31]
v_pk_add_f32 v[152:153], v[152:153], s[58:59]
v_pk_add_f32 v[154:155], v[154:155], s[58:59]
v_rcp_f32 v152, v152
v_rcp_f32 v153, v153
v_rcp_f32 v154, v154
v_rcp_f32 v155, v155
s_nop 0
v_pk_mul_f32 v[12:13], v[12:13], v[152:153]
v_pk_mul_f32 v[14:15], v[14:15], v[154:155]
v_cvt_pk_bf16_f32 v158, v12, v13
v_cvt_pk_bf16_f32 v159, v14, v15
ds_write_b64 v6, v[158:159] offset:1024
v_pk_mul_f32 v[152:153], v[16:17], s[56:57]
v_pk_mul_f32 v[154:155], v[18:19], s[56:57]
v_exp_f32 v152, v152
v_exp_f32 v153, v153
v_exp_f32 v154, v154
v_exp_f32 v155, v155
v_pk_mul_f32 v[16:17], v[16:17], v[32:33]
v_pk_mul_f32 v[18:19], v[18:19], v[34:35]
v_pk_add_f32 v[152:153], v[152:153], s[58:59]
v_pk_add_f32 v[154:155], v[154:155], s[58:59]
v_rcp_f32 v152, v152
v_rcp_f32 v153, v153
v_rcp_f32 v154, v154
v_rcp_f32 v155, v155
s_nop 0
v_pk_mul_f32 v[16:17], v[16:17], v[152:153]
v_pk_mul_f32 v[18:19], v[18:19], v[154:155]
v_cvt_pk_bf16_f32 v156, v16, v17
v_cvt_pk_bf16_f32 v157, v18, v19
ds_write_b64 v6, v[156:157] offset:2048
v_pk_mul_f32 v[152:153], v[20:21], s[56:57]
v_pk_mul_f32 v[154:155], v[22:23], s[56:57]
v_exp_f32 v152, v152
v_exp_f32 v153, v153
v_exp_f32 v154, v154
v_exp_f32 v155, v155
v_pk_mul_f32 v[20:21], v[20:21], v[36:37]
v_pk_mul_f32 v[22:23], v[22:23], v[38:39]
v_pk_add_f32 v[152:153], v[152:153], s[58:59]
v_pk_add_f32 v[154:155], v[154:155], s[58:59]
v_rcp_f32 v152, v152
v_rcp_f32 v153, v153
v_rcp_f32 v154, v154
v_rcp_f32 v155, v155
s_nop 0
v_pk_mul_f32 v[20:21], v[20:21], v[152:153]
v_pk_mul_f32 v[22:23], v[22:23], v[154:155]
v_cvt_pk_bf16_f32 v158, v20, v21
v_cvt_pk_bf16_f32 v159, v22, v23
ds_write_b64 v6, v[158:159] offset:3072
s_add_u32 s29, s28, 1
s_lshr_b32 s25, s29, 1
s_lshl_b32 s25, s25, 12
s_and_b32 s29, s29, 1
s_lshl_b32 s29, s29, 3
s_add_u32 s25, s25, s29
s_add_u32 s25, s25, 73728
v_add_u32 v6, s25, v4
v_pk_mul_f32 v[152:153], v[40:41], s[56:57]
v_pk_mul_f32 v[154:155], v[42:43], s[56:57]
v_exp_f32 v152, v152
v_exp_f32 v153, v153
v_exp_f32 v154, v154
v_exp_f32 v155, v155
v_pk_mul_f32 v[40:41], v[40:41], v[56:57]
v_pk_mul_f32 v[42:43], v[42:43], v[58:59]
v_pk_add_f32 v[152:153], v[152:153], s[58:59]
v_pk_add_f32 v[154:155], v[154:155], s[58:59]
v_rcp_f32 v152, v152
v_rcp_f32 v153, v153
v_rcp_f32 v154, v154
v_rcp_f32 v155, v155
s_nop 0
v_pk_mul_f32 v[40:41], v[40:41], v[152:153]
v_pk_mul_f32 v[42:43], v[42:43], v[154:155]
v_cvt_pk_bf16_f32 v156, v40, v41
v_cvt_pk_bf16_f32 v157, v42, v43
ds_write_b64 v6, v[156:157] offset:0
v_pk_mul_f32 v[152:153], v[44:45], s[56:57]
v_pk_mul_f32 v[154:155], v[46:47], s[56:57]
v_exp_f32 v152, v152
v_exp_f32 v153, v153
v_exp_f32 v154, v154
v_exp_f32 v155, v155
v_pk_mul_f32 v[44:45], v[44:45], v[60:61]
v_pk_mul_f32 v[46:47], v[46:47], v[62:63]
v_pk_add_f32 v[152:153], v[152:153], s[58:59]
v_pk_add_f32 v[154:155], v[154:155], s[58:59]
v_rcp_f32 v152, v152
v_rcp_f32 v153, v153
v_rcp_f32 v154, v154
v_rcp_f32 v155, v155
s_nop 0
v_pk_mul_f32 v[44:45], v[44:45], v[152:153]
v_pk_mul_f32 v[46:47], v[46:47], v[154:155]
v_cvt_pk_bf16_f32 v158, v44, v45
v_cvt_pk_bf16_f32 v159, v46, v47
ds_write_b64 v6, v[158:159] offset:1024
v_pk_mul_f32 v[152:153], v[48:49], s[56:57]
v_pk_mul_f32 v[154:155], v[50:51], s[56:57]
v_exp_f32 v152, v152
v_exp_f32 v153, v153
v_exp_f32 v154, v154
v_exp_f32 v155, v155
v_pk_mul_f32 v[48:49], v[48:49], v[64:65]
v_pk_mul_f32 v[50:51], v[50:51], v[66:67]
v_pk_add_f32 v[152:153], v[152:153], s[58:59]
v_pk_add_f32 v[154:155], v[154:155], s[58:59]
v_rcp_f32 v152, v152
v_rcp_f32 v153, v153
v_rcp_f32 v154, v154
v_rcp_f32 v155, v155
s_nop 0
v_pk_mul_f32 v[48:49], v[48:49], v[152:153]
v_pk_mul_f32 v[50:51], v[50:51], v[154:155]
v_cvt_pk_bf16_f32 v156, v48, v49
v_cvt_pk_bf16_f32 v157, v50, v51
ds_write_b64 v6, v[156:157] offset:2048
v_pk_mul_f32 v[152:153], v[52:53], s[56:57]
v_pk_mul_f32 v[154:155], v[54:55], s[56:57]
v_exp_f32 v152, v152
v_exp_f32 v153, v153
v_exp_f32 v154, v154
v_exp_f32 v155, v155
v_pk_mul_f32 v[52:53], v[52:53], v[68:69]
v_pk_mul_f32 v[54:55], v[54:55], v[70:71]
v_pk_add_f32 v[152:153], v[152:153], s[58:59]
v_pk_add_f32 v[154:155], v[154:155], s[58:59]
v_rcp_f32 v152, v152
v_rcp_f32 v153, v153
v_rcp_f32 v154, v154
v_rcp_f32 v155, v155
s_nop 0
v_pk_mul_f32 v[52:53], v[52:53], v[152:153]
v_pk_mul_f32 v[54:55], v[54:55], v[154:155]
v_cvt_pk_bf16_f32 v158, v52, v53
v_cvt_pk_bf16_f32 v159, v54, v55
ds_write_b64 v6, v[158:159] offset:3072
s_add_u32 s29, s28, 2
s_lshr_b32 s25, s29, 1
s_lshl_b32 s25, s25, 12
s_and_b32 s29, s29, 1
s_lshl_b32 s29, s29, 3
s_add_u32 s25, s25, s29
s_add_u32 s25, s25, 73728
v_add_u32 v6, s25, v4
v_pk_mul_f32 v[152:153], v[72:73], s[56:57]
v_pk_mul_f32 v[154:155], v[74:75], s[56:57]
v_exp_f32 v152, v152
v_exp_f32 v153, v153
v_exp_f32 v154, v154
v_exp_f32 v155, v155
v_pk_mul_f32 v[72:73], v[72:73], v[88:89]
v_pk_mul_f32 v[74:75], v[74:75], v[90:91]
v_pk_add_f32 v[152:153], v[152:153], s[58:59]
v_pk_add_f32 v[154:155], v[154:155], s[58:59]
v_rcp_f32 v152, v152
v_rcp_f32 v153, v153
v_rcp_f32 v154, v154
v_rcp_f32 v155, v155
s_nop 0
v_pk_mul_f32 v[72:73], v[72:73], v[152:153]
v_pk_mul_f32 v[74:75], v[74:75], v[154:155]
v_cvt_pk_bf16_f32 v156, v72, v73
v_cvt_pk_bf16_f32 v157, v74, v75
ds_write_b64 v6, v[156:157] offset:0
v_pk_mul_f32 v[152:153], v[76:77], s[56:57]
v_pk_mul_f32 v[154:155], v[78:79], s[56:57]
v_exp_f32 v152, v152
v_exp_f32 v153, v153
v_exp_f32 v154, v154
v_exp_f32 v155, v155
v_pk_mul_f32 v[76:77], v[76:77], v[92:93]
v_pk_mul_f32 v[78:79], v[78:79], v[94:95]
v_pk_add_f32 v[152:153], v[152:153], s[58:59]
v_pk_add_f32 v[154:155], v[154:155], s[58:59]
v_rcp_f32 v152, v152
v_rcp_f32 v153, v153
v_rcp_f32 v154, v154
v_rcp_f32 v155, v155
s_nop 0
v_pk_mul_f32 v[76:77], v[76:77], v[152:153]
v_pk_mul_f32 v[78:79], v[78:79], v[154:155]
v_cvt_pk_bf16_f32 v158, v76, v77
v_cvt_pk_bf16_f32 v159, v78, v79
ds_write_b64 v6, v[158:159] offset:1024
v_pk_mul_f32 v[152:153], v[80:81], s[56:57]
v_pk_mul_f32 v[154:155], v[82:83], s[56:57]
v_exp_f32 v152, v152
v_exp_f32 v153, v153
v_exp_f32 v154, v154
v_exp_f32 v155, v155
v_pk_mul_f32 v[80:81], v[80:81], v[96:97]
v_pk_mul_f32 v[82:83], v[82:83], v[98:99]
v_pk_add_f32 v[152:153], v[152:153], s[58:59]
v_pk_add_f32 v[154:155], v[154:155], s[58:59]
v_rcp_f32 v152, v152
v_rcp_f32 v153, v153
v_rcp_f32 v154, v154
v_rcp_f32 v155, v155
s_nop 0
v_pk_mul_f32 v[80:81], v[80:81], v[152:153]
v_pk_mul_f32 v[82:83], v[82:83], v[154:155]
v_cvt_pk_bf16_f32 v156, v80, v81
v_cvt_pk_bf16_f32 v157, v82, v83
ds_write_b64 v6, v[156:157] offset:2048
v_pk_mul_f32 v[152:153], v[84:85], s[56:57]
v_pk_mul_f32 v[154:155], v[86:87], s[56:57]
v_exp_f32 v152, v152
v_exp_f32 v153, v153
v_exp_f32 v154, v154
v_exp_f32 v155, v155
v_pk_mul_f32 v[84:85], v[84:85], v[100:101]
v_pk_mul_f32 v[86:87], v[86:87], v[102:103]
v_pk_add_f32 v[152:153], v[152:153], s[58:59]
v_pk_add_f32 v[154:155], v[154:155], s[58:59]
v_rcp_f32 v152, v152
v_rcp_f32 v153, v153
v_rcp_f32 v154, v154
v_rcp_f32 v155, v155
s_nop 0
v_pk_mul_f32 v[84:85], v[84:85], v[152:153]
v_pk_mul_f32 v[86:87], v[86:87], v[154:155]
v_cvt_pk_bf16_f32 v158, v84, v85
v_cvt_pk_bf16_f32 v159, v86, v87
ds_write_b64 v6, v[158:159] offset:3072
s_waitcnt lgkmcnt(0)
s_lshr_b32 s28, s22, 2
s_lshl_b32 s28, s28, 2
s_add_u32 s28, s28, 147460
s_mov_b64 exec, 1
v_mov_b32 v6, s28
v_mov_b32 v56, 1
ds_add_u32 v6, v56
s_mov_b64 exec, -1
v_mov_b32 v6, 147456
k5_hw0:
ds_read_b32 v56, v6 offset:4
s_waitcnt lgkmcnt(0)
v_readfirstlane_b32 s28, v56
s_nop 0
s_cmp_ge_u32 s28, 4
s_cbranch_scc0 k5_hw0
s_setprio 1
v_add_u32 v5, 73728, v4
ds_read_b128 v[152:155], v5 offset:0
ds_read_b128 v[156:159], v5 offset:1024
ds_read_b128 v[160:163], v5 offset:2048
ds_read_b128 v[164:167], v5 offset:3072
s_waitcnt vmcnt(9) lgkmcnt(3)
v_mfma_f32_16x16x32_bf16 v[8:11], v[104:107], v[152:155], 0
v_mfma_f32_16x16x32_bf16 v[24:27], v[108:111], v[152:155], 0
v_mfma_f32_16x16x32_bf16 v[40:43], v[112:115], v[152:155], 0
ds_read_b128 v[152:155], v5 offset:4096
s_waitcnt lgkmcnt(3)
v_mfma_f32_16x16x32_bf16 v[12:15], v[104:107], v[156:159], 0
v_mfma_f32_16x16x32_bf16 v[28:31], v[108:111], v[156:159], 0
v_mfma_f32_16x16x32_bf16 v[44:47], v[112:115], v[156:159], 0
ds_read_b128 v[156:159], v5 offset:5120
s_waitcnt lgkmcnt(3)
v_mfma_f32_16x16x32_bf16 v[16:19], v[104:107], v[160:163], 0
v_mfma_f32_16x16x32_bf16 v[32:35], v[108:111], v[160:163], 0
v_mfma_f32_16x16x32_bf16 v[48:51], v[112:115], v[160:163], 0
ds_read_b128 v[160:163], v5 offset:6144
s_waitcnt lgkmcnt(3)
v_mfma_f32_16x16x32_bf16 v[20:23], v[104:107], v[164:167], 0
buffer_load_dwordx4 v[104:107], v4, s[16:19], s41 offen offset:0 sc1
v_mfma_f32_16x16x32_bf16 v[36:39], v[108:111], v[164:167], 0
buffer_load_dwordx4 v[108:111], v4, s[16:19], s41 offen offset:1024 sc1
v_mfma_f32_16x16x32_bf16 v[52:55], v[112:115], v[164:167], 0
buffer_load_dwordx4 v[112:115], v4, s[16:19], s41 offen offset:2048 sc1
ds_read_b128 v[164:167], v5 offset:7168
s_add_u32 s41, s41, 3072
v_add_u32 v5, 8192, v5
s_waitcnt vmcnt(9) lgkmcnt(3)
v_mfma_f32_16x16x32_bf16 v[8:11], v[116:119], v[152:155], v[8:11]
v_mfma_f32_16x16x32_bf16 v[24:27], v[120:123], v[152:155], v[24:27]
v_mfma_f32_16x16x32_bf16 v[40:43], v[124:127], v[152:155], v[40:43]
ds_read_b128 v[152:155], v5 offset:0
s_waitcnt lgkmcnt(3)
v_mfma_f32_16x16x32_bf16 v[12:15], v[116:119], v[156:159], v[12:15]
v_mfma_f32_16x16x32_bf16 v[28:31], v[120:123], v[156:159], v[28:31]
v_mfma_f32_16x16x32_bf16 v[44:47], v[124:127], v[156:159], v[44:47]
ds_read_b128 v[156:159], v5 offset:1024
s_waitcnt lgkmcnt(3)
v_mfma_f32_16x16x32_bf16 v[16:19], v[116:119], v[160:163], v[16:19]
v_mfma_f32_16x16x32_bf16 v[32:35], v[120:123], v[160:163], v[32:35]
v_mfma_f32_16x16x32_bf16 v[48:51], v[124:127], v[160:163], v[48:51]
ds_read_b128 v[160:163], v5 offset:2048
s_waitcnt lgkmcnt(3)
v_mfma_f32_16x16x32_bf16 v[20:23], v[116:119], v[164:167], v[20:23]
buffer_load_dwordx4 v[116:119], v4, s[16:19], s41 offen offset:0 sc1
v_mfma_f32_16x16x32_bf16 v[36:39], v[120:123], v[164:167], v[36:39]
buffer_load_dwordx4 v[120:123], v4, s[16:19], s41 offen offset:1024 sc1
v_mfma_f32_16x16x32_bf16 v[52:55], v[124:127], v[164:167], v[52:55]
buffer_load_dwordx4 v[124:127], v4, s[16:19], s41 offen offset:2048 sc1
ds_read_b128 v[164:167], v5 offset:3072
s_add_u32 s41, s41, 3072
s_waitcnt vmcnt(9) lgkmcnt(3)
v_mfma_f32_16x16x32_bf16 v[8:11], v[128:131], v[152:155], v[8:11]
v_mfma_f32_16x16x32_bf16 v[24:27], v[132:135], v[152:155], v[24:27]
v_mfma_f32_16x16x32_bf16 v[40:43], v[136:139], v[152:155], v[40:43]
ds_read_b128 v[152:155], v5 offset:4096
s_waitcnt lgkmcnt(3)
v_mfma_f32_16x16x32_bf16 v[12:15], v[128:131], v[156:159], v[12:15]
v_mfma_f32_16x16x32_bf16 v[28:31], v[132:135], v[156:159], v[28:31]
v_mfma_f32_16x16x32_bf16 v[44:47], v[136:139], v[156:159], v[44:47]
ds_read_b128 v[156:159], v5 offset:5120
s_waitcnt lgkmcnt(3)
v_mfma_f32_16x16x32_bf16 v[16:19], v[128:131], v[160:163], v[16:19]
v_mfma_f32_16x16x32_bf16 v[32:35], v[132:135], v[160:163], v[32:35]
v_mfma_f32_16x16x32_bf16 v[48:51], v[136:139], v[160:163], v[48:51]
ds_read_b128 v[160:163], v5 offset:6144
s_waitcnt lgkmcnt(3)
v_mfma_f32_16x16x32_bf16 v[20:23], v[128:131], v[164:167], v[20:23]
buffer_load_dwordx4 v[128:131], v4, s[16:19], s41 offen offset:0 sc1
v_mfma_f32_16x16x32_bf16 v[36:39], v[132:135], v[164:167], v[36:39]
buffer_load_dwordx4 v[132:135], v4, s[16:19], s41 offen offset:1024 sc1
v_mfma_f32_16x16x32_bf16 v[52:55], v[136:139], v[164:167], v[52:55]
buffer_load_dwordx4 v[136:139], v4, s[16:19], s41 offen offset:2048 sc1
ds_read_b128 v[164:167], v5 offset:7168
s_add_u32 s41, s41, 3072
v_add_u32 v5, 8192, v5
s_waitcnt vmcnt(9) lgkmcnt(3)
v_mfma_f32_16x16x32_bf16 v[8:11], v[140:143], v[152:155], v[8:11]
v_mfma_f32_16x16x32_bf16 v[24:27], v[144:147], v[152:155], v[24:27]
v_mfma_f32_16x16x32_bf16 v[40:43], v[148:151], v[152:155], v[40:43]
ds_read_b128 v[152:155], v5 offset:0
s_waitcnt lgkmcnt(3)
v_mfma_f32_16x16x32_bf16 v[12:15], v[140:143], v[156:159], v[12:15]
v_mfma_f32_16x16x32_bf16 v[28:31], v[144:147], v[156:159], v[28:31]
v_mfma_f32_16x16x32_bf16 v[44:47], v[148:151], v[156:159], v[44:47]
ds_read_b128 v[156:159], v5 offset:1024
s_waitcnt lgkmcnt(3)
v_mfma_f32_16x16x32_bf16 v[16:19], v[140:143], v[160:163], v[16:19]
v_mfma_f32_16x16x32_bf16 v[32:35], v[144:147], v[160:163], v[32:35]
v_mfma_f32_16x16x32_bf16 v[48:51], v[148:151], v[160:163], v[48:51]
ds_read_b128 v[160:163], v5 offset:2048
s_waitcnt lgkmcnt(3)
v_mfma_f32_16x16x32_bf16 v[20:23], v[140:143], v[164:167], v[20:23]
buffer_load_dwordx4 v[140:143], v4, s[16:19], s41 offen offset:0 sc1
v_mfma_f32_16x16x32_bf16 v[36:39], v[144:147], v[164:167], v[36:39]
buffer_load_dwordx4 v[144:147], v4, s[16:19], s41 offen offset:1024 sc1
v_mfma_f32_16x16x32_bf16 v[52:55], v[148:151], v[164:167], v[52:55]
buffer_load_dwordx4 v[148:151], v4, s[16:19], s41 offen offset:2048 sc1
ds_read_b128 v[164:167], v5 offset:3072
s_add_u32 s41, s41, 3072
s_waitcnt vmcnt(9) lgkmcnt(3)
v_mfma_f32_16x16x32_bf16 v[8:11], v[104:107], v[152:155], v[8:11]
v_mfma_f32_16x16x32_bf16 v[24:27], v[108:111], v[152:155], v[24:27]
v_mfma_f32_16x16x32_bf16 v[40:43], v[112:115], v[152:155], v[40:43]
ds_read_b128 v[152:155], v5 offset:4096
s_waitcnt lgkmcnt(3)
v_mfma_f32_16x16x32_bf16 v[12:15], v[104:107], v[156:159], v[12:15]
v_mfma_f32_16x16x32_bf16 v[28:31], v[108:111], v[156:159], v[28:31]
v_mfma_f32_16x16x32_bf16 v[44:47], v[112:115], v[156:159], v[44:47]
ds_read_b128 v[156:159], v5 offset:5120
s_waitcnt lgkmcnt(3)
v_mfma_f32_16x16x32_bf16 v[16:19], v[104:107], v[160:163], v[16:19]
v_mfma_f32_16x16x32_bf16 v[32:35], v[108:111], v[160:163], v[32:35]
v_mfma_f32_16x16x32_bf16 v[48:51], v[112:115], v[160:163], v[48:51]
ds_read_b128 v[160:163], v5 offset:6144
s_waitcnt lgkmcnt(3)
v_mfma_f32_16x16x32_bf16 v[20:23], v[104:107], v[164:167], v[20:23]
buffer_load_dwordx4 v[104:107], v4, s[16:19], s41 offen offset:0 sc1
v_mfma_f32_16x16x32_bf16 v[36:39], v[108:111], v[164:167], v[36:39]
buffer_load_dwordx4 v[108:111], v4, s[16:19], s41 offen offset:1024 sc1
v_mfma_f32_16x16x32_bf16 v[52:55], v[112:115], v[164:167], v[52:55]
buffer_load_dwordx4 v[112:115], v4, s[16:19], s41 offen offset:2048 sc1
ds_read_b128 v[164:167], v5 offset:7168
s_add_u32 s41, s41, 3072
v_add_u32 v5, 8192, v5
k5_hw1:
ds_read_b32 v56, v6 offset:8
s_waitcnt lgkmcnt(0)
v_readfirstlane_b32 s28, v56
s_nop 0
s_cmp_ge_u32 s28, 4
s_cbranch_scc0 k5_hw1
s_waitcnt vmcnt(9) lgkmcnt(3)
v_mfma_f32_16x16x32_bf16 v[8:11], v[116:119], v[152:155], v[8:11]
v_mfma_f32_16x16x32_bf16 v[24:27], v[120:123], v[152:155], v[24:27]
v_mfma_f32_16x16x32_bf16 v[40:43], v[124:127], v[152:155], v[40:43]
ds_read_b128 v[152:155], v5 offset:0
s_waitcnt lgkmcnt(3)
v_mfma_f32_16x16x32_bf16 v[12:15], v[116:119], v[156:159], v[12:15]
v_mfma_f32_16x16x32_bf16 v[28:31], v[120:123], v[156:159], v[28:31]
v_mfma_f32_16x16x32_bf16 v[44:47], v[124:127], v[156:159], v[44:47]
ds_read_b128 v[156:159], v5 offset:1024
s_waitcnt lgkmcnt(3)
v_mfma_f32_16x16x32_bf16 v[16:19], v[116:119], v[160:163], v[16:19]
v_mfma_f32_16x16x32_bf16 v[32:35], v[120:123], v[160:163], v[32:35]
v_mfma_f32_16x16x32_bf16 v[48:51], v[124:127], v[160:163], v[48:51]
ds_read_b128 v[160:163], v5 offset:2048
s_waitcnt lgkmcnt(3)
v_mfma_f32_16x16x32_bf16 v[20:23], v[116:119], v[164:167], v[20:23]
buffer_load_dwordx4 v[116:119], v4, s[16:19], s41 offen offset:0 sc1
v_mfma_f32_16x16x32_bf16 v[36:39], v[120:123], v[164:167], v[36:39]
buffer_load_dwordx4 v[120:123], v4, s[16:19], s41 offen offset:1024 sc1
v_mfma_f32_16x16x32_bf16 v[52:55], v[124:127], v[164:167], v[52:55]
buffer_load_dwordx4 v[124:127], v4, s[16:19], s41 offen offset:2048 sc1
ds_read_b128 v[164:167], v5 offset:3072
s_add_u32 s41, s41, 3072
s_waitcnt vmcnt(9) lgkmcnt(3)
v_mfma_f32_16x16x32_bf16 v[8:11], v[128:131], v[152:155], v[8:11]
v_mfma_f32_16x16x32_bf16 v[24:27], v[132:135], v[152:155], v[24:27]
v_mfma_f32_16x16x32_bf16 v[40:43], v[136:139], v[152:155], v[40:43]
ds_read_b128 v[152:155], v5 offset:4096
s_waitcnt lgkmcnt(3)
v_mfma_f32_16x16x32_bf16 v[12:15], v[128:131], v[156:159], v[12:15]
v_mfma_f32_16x16x32_bf16 v[28:31], v[132:135], v[156:159], v[28:31]
v_mfma_f32_16x16x32_bf16 v[44:47], v[136:139], v[156:159], v[44:47]
ds_read_b128 v[156:159], v5 offset:5120
s_waitcnt lgkmcnt(3)
v_mfma_f32_16x16x32_bf16 v[16:19], v[128:131], v[160:163], v[16:19]
v_mfma_f32_16x16x32_bf16 v[32:35], v[132:135], v[160:163], v[32:35]
v_mfma_f32_16x16x32_bf16 v[48:51], v[136:139], v[160:163], v[48:51]
ds_read_b128 v[160:163], v5 offset:6144
s_waitcnt lgkmcnt(3)
v_mfma_f32_16x16x32_bf16 v[20:23], v[128:131], v[164:167], v[20:23]
buffer_load_dwordx4 v[128:131], v4, s[16:19], s41 offen offset:0 sc1
v_mfma_f32_16x16x32_bf16 v[36:39], v[132:135], v[164:167], v[36:39]
buffer_load_dwordx4 v[132:135], v4, s[16:19], s41 offen offset:1024 sc1
v_mfma_f32_16x16x32_bf16 v[52:55], v[136:139], v[164:167], v[52:55]
buffer_load_dwordx4 v[136:139], v4, s[16:19], s41 offen offset:2048 sc1
ds_read_b128 v[164:167], v5 offset:7168
s_add_u32 s41, s41, 3072
v_add_u32 v5, 8192, v5
s_waitcnt vmcnt(9) lgkmcnt(3)
v_mfma_f32_16x16x32_bf16 v[8:11], v[140:143], v[152:155], v[8:11]
v_mfma_f32_16x16x32_bf16 v[24:27], v[144:147], v[152:155], v[24:27]
v_mfma_f32_16x16x32_bf16 v[40:43], v[148:151], v[152:155], v[40:43]
ds_read_b128 v[152:155], v5 offset:0
s_waitcnt lgkmcnt(3)
v_mfma_f32_16x16x32_bf16 v[12:15], v[140:143], v[156:159], v[12:15]
v_mfma_f32_16x16x32_bf16 v[28:31], v[144:147], v[156:159], v[28:31]
v_mfma_f32_16x16x32_bf16 v[44:47], v[148:151], v[156:159], v[44:47]
ds_read_b128 v[156:159], v5 offset:1024
s_waitcnt lgkmcnt(3)
v_mfma_f32_16x16x32_bf16 v[16:19], v[140:143], v[160:163], v[16:19]
v_mfma_f32_16x16x32_bf16 v[32:35], v[144:147], v[160:163], v[32:35]
v_mfma_f32_16x16x32_bf16 v[48:51], v[148:151], v[160:163], v[48:51]
ds_read_b128 v[160:163], v5 offset:2048
s_waitcnt lgkmcnt(3)
v_mfma_f32_16x16x32_bf16 v[20:23], v[140:143], v[164:167], v[20:23]
buffer_load_dwordx4 v[140:143], v4, s[16:19], s41 offen offset:0 sc1
v_mfma_f32_16x16x32_bf16 v[36:39], v[144:147], v[164:167], v[36:39]
buffer_load_dwordx4 v[144:147], v4, s[16:19], s41 offen offset:1024 sc1
v_mfma_f32_16x16x32_bf16 v[52:55], v[148:151], v[164:167], v[52:55]
buffer_load_dwordx4 v[148:151], v4, s[16:19], s41 offen offset:2048 sc1
ds_read_b128 v[164:167], v5 offset:3072
s_add_u32 s41, s41, 3072
s_waitcnt vmcnt(9) lgkmcnt(3)
v_mfma_f32_16x16x32_bf16 v[8:11], v[104:107], v[152:155], v[8:11]
v_mfma_f32_16x16x32_bf16 v[24:27], v[108:111], v[152:155], v[24:27]
v_mfma_f32_16x16x32_bf16 v[40:43], v[112:115], v[152:155], v[40:43]
ds_read_b128 v[152:155], v5 offset:4096
s_waitcnt lgkmcnt(3)
v_mfma_f32_16x16x32_bf16 v[12:15], v[104:107], v[156:159], v[12:15]
v_mfma_f32_16x16x32_bf16 v[28:31], v[108:111], v[156:159], v[28:31]
v_mfma_f32_16x16x32_bf16 v[44:47], v[112:115], v[156:159], v[44:47]
ds_read_b128 v[156:159], v5 offset:5120
s_waitcnt lgkmcnt(3)
v_mfma_f32_16x16x32_bf16 v[16:19], v[104:107], v[160:163], v[16:19]
v_mfma_f32_16x16x32_bf16 v[32:35], v[108:111], v[160:163], v[32:35]
v_mfma_f32_16x16x32_bf16 v[48:51], v[112:115], v[160:163], v[48:51]
ds_read_b128 v[160:163], v5 offset:6144
s_waitcnt lgkmcnt(3)
v_mfma_f32_16x16x32_bf16 v[20:23], v[104:107], v[164:167], v[20:23]
buffer_load_dwordx4 v[104:107], v4, s[16:19], s41 offen offset:0 sc1
v_mfma_f32_16x16x32_bf16 v[36:39], v[108:111], v[164:167], v[36:39]
buffer_load_dwordx4 v[108:111], v4, s[16:19], s41 offen offset:1024 sc1
v_mfma_f32_16x16x32_bf16 v[52:55], v[112:115], v[164:167], v[52:55]
buffer_load_dwordx4 v[112:115], v4, s[16:19], s41 offen offset:2048 sc1
ds_read_b128 v[164:167], v5 offset:7168
s_add_u32 s41, s41, 3072
v_add_u32 v5, 8192, v5
s_waitcnt vmcnt(9) lgkmcnt(3)
v_mfma_f32_16x16x32_bf16 v[8:11], v[116:119], v[152:155], v[8:11]
v_mfma_f32_16x16x32_bf16 v[24:27], v[120:123], v[152:155], v[24:27]
v_mfma_f32_16x16x32_bf16 v[40:43], v[124:127], v[152:155], v[40:43]
ds_read_b128 v[152:155], v5 offset:0
s_waitcnt lgkmcnt(3)
v_mfma_f32_16x16x32_bf16 v[12:15], v[116:119], v[156:159], v[12:15]
v_mfma_f32_16x16x32_bf16 v[28:31], v[120:123], v[156:159], v[28:31]
v_mfma_f32_16x16x32_bf16 v[44:47], v[124:127], v[156:159], v[44:47]
ds_read_b128 v[156:159], v5 offset:1024
s_waitcnt lgkmcnt(3)
v_mfma_f32_16x16x32_bf16 v[16:19], v[116:119], v[160:163], v[16:19]
v_mfma_f32_16x16x32_bf16 v[32:35], v[120:123], v[160:163], v[32:35]
v_mfma_f32_16x16x32_bf16 v[48:51], v[124:127], v[160:163], v[48:51]
ds_read_b128 v[160:163], v5 offset:2048
s_waitcnt lgkmcnt(3)
v_mfma_f32_16x16x32_bf16 v[20:23], v[116:119], v[164:167], v[20:23]
buffer_load_dwordx4 v[116:119], v4, s[16:19], s41 offen offset:0 sc1
v_mfma_f32_16x16x32_bf16 v[36:39], v[120:123], v[164:167], v[36:39]
buffer_load_dwordx4 v[120:123], v4, s[16:19], s41 offen offset:1024 sc1
v_mfma_f32_16x16x32_bf16 v[52:55], v[124:127], v[164:167], v[52:55]
buffer_load_dwordx4 v[124:127], v4, s[16:19], s41 offen offset:2048 sc1
ds_read_b128 v[164:167], v5 offset:3072
s_add_u32 s41, s41, 3072
s_waitcnt vmcnt(9) lgkmcnt(3)
v_mfma_f32_16x16x32_bf16 v[8:11], v[128:131], v[152:155], v[8:11]
v_mfma_f32_16x16x32_bf16 v[24:27], v[132:135], v[152:155], v[24:27]
v_mfma_f32_16x16x32_bf16 v[40:43], v[136:139], v[152:155], v[40:43]
ds_read_b128 v[152:155], v5 offset:4096
s_waitcnt lgkmcnt(3)
v_mfma_f32_16x16x32_bf16 v[12:15], v[128:131], v[156:159], v[12:15]
v_mfma_f32_16x16x32_bf16 v[28:31], v[132:135], v[156:159], v[28:31]
v_mfma_f32_16x16x32_bf16 v[44:47], v[136:139], v[156:159], v[44:47]
ds_read_b128 v[156:159], v5 offset:5120
s_waitcnt lgkmcnt(3)
v_mfma_f32_16x16x32_bf16 v[16:19], v[128:131], v[160:163], v[16:19]
v_mfma_f32_16x16x32_bf16 v[32:35], v[132:135], v[160:163], v[32:35]
v_mfma_f32_16x16x32_bf16 v[48:51], v[136:139], v[160:163], v[48:51]
ds_read_b128 v[160:163], v5 offset:6144
s_waitcnt lgkmcnt(3)
v_mfma_f32_16x16x32_bf16 v[20:23], v[128:131], v[164:167], v[20:23]
buffer_load_dwordx4 v[128:131], v4, s[16:19], s41 offen offset:0 sc1
v_mfma_f32_16x16x32_bf16 v[36:39], v[132:135], v[164:167], v[36:39]
buffer_load_dwordx4 v[132:135], v4, s[16:19], s41 offen offset:1024 sc1
v_mfma_f32_16x16x32_bf16 v[52:55], v[136:139], v[164:167], v[52:55]
buffer_load_dwordx4 v[136:139], v4, s[16:19], s41 offen offset:2048 sc1
ds_read_b128 v[164:167], v5 offset:7168
s_add_u32 s41, s41, 3072
v_add_u32 v5, 8192, v5
k5_hw2:
ds_read_b32 v56, v6 offset:12
s_waitcnt lgkmcnt(0)
v_readfirstlane_b32 s28, v56
s_nop 0
s_cmp_ge_u32 s28, 4
s_cbranch_scc0 k5_hw2
s_waitcnt vmcnt(9) lgkmcnt(3)
v_mfma_f32_16x16x32_bf16 v[8:11], v[140:143], v[152:155], v[8:11]
v_mfma_f32_16x16x32_bf16 v[24:27], v[144:147], v[152:155], v[24:27]
v_mfma_f32_16x16x32_bf16 v[40:43], v[148:151], v[152:155], v[40:43]
ds_read_b128 v[152:155], v5 offset:0
s_waitcnt lgkmcnt(3)
v_mfma_f32_16x16x32_bf16 v[12:15], v[140:143], v[156:159], v[12:15]
v_mfma_f32_16x16x32_bf16 v[28:31], v[144:147], v[156:159], v[28:31]
v_mfma_f32_16x16x32_bf16 v[44:47], v[148:151], v[156:159], v[44:47]
ds_read_b128 v[156:159], v5 offset:1024
s_waitcnt lgkmcnt(3)
v_mfma_f32_16x16x32_bf16 v[16:19], v[140:143], v[160:163], v[16:19]
v_mfma_f32_16x16x32_bf16 v[32:35], v[144:147], v[160:163], v[32:35]
v_mfma_f32_16x16x32_bf16 v[48:51], v[148:151], v[160:163], v[48:51]
ds_read_b128 v[160:163], v5 offset:2048
s_waitcnt lgkmcnt(3)
v_mfma_f32_16x16x32_bf16 v[20:23], v[140:143], v[164:167], v[20:23]
buffer_load_dwordx4 v[140:143], v4, s[16:19], s41 offen offset:0 sc1
v_mfma_f32_16x16x32_bf16 v[36:39], v[144:147], v[164:167], v[36:39]
buffer_load_dwordx4 v[144:147], v4, s[16:19], s41 offen offset:1024 sc1
v_mfma_f32_16x16x32_bf16 v[52:55], v[148:151], v[164:167], v[52:55]
buffer_load_dwordx4 v[148:151], v4, s[16:19], s41 offen offset:2048 sc1
ds_read_b128 v[164:167], v5 offset:3072
s_add_u32 s41, s41, 3072
s_waitcnt vmcnt(9) lgkmcnt(3)
v_mfma_f32_16x16x32_bf16 v[8:11], v[104:107], v[152:155], v[8:11]
v_mfma_f32_16x16x32_bf16 v[24:27], v[108:111], v[152:155], v[24:27]
v_mfma_f32_16x16x32_bf16 v[40:43], v[112:115], v[152:155], v[40:43]
ds_read_b128 v[152:155], v5 offset:4096
s_waitcnt lgkmcnt(3)
v_mfma_f32_16x16x32_bf16 v[12:15], v[104:107], v[156:159], v[12:15]
v_mfma_f32_16x16x32_bf16 v[28:31], v[108:111], v[156:159], v[28:31]
v_mfma_f32_16x16x32_bf16 v[44:47], v[112:115], v[156:159], v[44:47]
ds_read_b128 v[156:159], v5 offset:5120
s_waitcnt lgkmcnt(3)
v_mfma_f32_16x16x32_bf16 v[16:19], v[104:107], v[160:163], v[16:19]
v_mfma_f32_16x16x32_bf16 v[32:35], v[108:111], v[160:163], v[32:35]
v_mfma_f32_16x16x32_bf16 v[48:51], v[112:115], v[160:163], v[48:51]
ds_read_b128 v[160:163], v5 offset:6144
s_waitcnt lgkmcnt(3)
v_mfma_f32_16x16x32_bf16 v[20:23], v[104:107], v[164:167], v[20:23]
buffer_load_dwordx4 v[104:107], v4, s[16:19], s41 offen offset:0 sc1
v_mfma_f32_16x16x32_bf16 v[36:39], v[108:111], v[164:167], v[36:39]
buffer_load_dwordx4 v[108:111], v4, s[16:19], s41 offen offset:1024 sc1
v_mfma_f32_16x16x32_bf16 v[52:55], v[112:115], v[164:167], v[52:55]
buffer_load_dwordx4 v[112:115], v4, s[16:19], s41 offen offset:2048 sc1
ds_read_b128 v[164:167], v5 offset:7168
s_add_u32 s41, s41, 3072
v_add_u32 v5, 8192, v5
s_waitcnt vmcnt(9) lgkmcnt(3)
v_mfma_f32_16x16x32_bf16 v[8:11], v[116:119], v[152:155], v[8:11]
v_mfma_f32_16x16x32_bf16 v[24:27], v[120:123], v[152:155], v[24:27]
v_mfma_f32_16x16x32_bf16 v[40:43], v[124:127], v[152:155], v[40:43]
ds_read_b128 v[152:155], v5 offset:0
s_waitcnt lgkmcnt(3)
v_mfma_f32_16x16x32_bf16 v[12:15], v[116:119], v[156:159], v[12:15]
v_mfma_f32_16x16x32_bf16 v[28:31], v[120:123], v[156:159], v[28:31]
v_mfma_f32_16x16x32_bf16 v[44:47], v[124:127], v[156:159], v[44:47]
ds_read_b128 v[156:159], v5 offset:1024
s_waitcnt lgkmcnt(3)
v_mfma_f32_16x16x32_bf16 v[16:19], v[116:119], v[160:163], v[16:19]
v_mfma_f32_16x16x32_bf16 v[32:35], v[120:123], v[160:163], v[32:35]
v_mfma_f32_16x16x32_bf16 v[48:51], v[124:127], v[160:163], v[48:51]
ds_read_b128 v[160:163], v5 offset:2048
s_waitcnt lgkmcnt(3)
v_mfma_f32_16x16x32_bf16 v[20:23], v[116:119], v[164:167], v[20:23]
buffer_load_dwordx4 v[116:119], v4, s[16:19], s41 offen offset:0 sc1
v_mfma_f32_16x16x32_bf16 v[36:39], v[120:123], v[164:167], v[36:39]
buffer_load_dwordx4 v[120:123], v4, s[16:19], s41 offen offset:1024 sc1
v_mfma_f32_16x16x32_bf16 v[52:55], v[124:127], v[164:167], v[52:55]
buffer_load_dwordx4 v[124:127], v4, s[16:19], s41 offen offset:2048 sc1
ds_read_b128 v[164:167], v5 offset:3072
s_add_u32 s41, s41, 3072
s_waitcnt vmcnt(9) lgkmcnt(3)
v_mfma_f32_16x16x32_bf16 v[8:11], v[128:131], v[152:155], v[8:11]
v_mfma_f32_16x16x32_bf16 v[24:27], v[132:135], v[152:155], v[24:27]
v_mfma_f32_16x16x32_bf16 v[40:43], v[136:139], v[152:155], v[40:43]
ds_read_b128 v[152:155], v5 offset:4096
s_waitcnt lgkmcnt(3)
v_mfma_f32_16x16x32_bf16 v[12:15], v[128:131], v[156:159], v[12:15]
v_mfma_f32_16x16x32_bf16 v[28:31], v[132:135], v[156:159], v[28:31]
v_mfma_f32_16x16x32_bf16 v[44:47], v[136:139], v[156:159], v[44:47]
ds_read_b128 v[156:159], v5 offset:5120
s_waitcnt lgkmcnt(3)
v_mfma_f32_16x16x32_bf16 v[16:19], v[128:131], v[160:163], v[16:19]
v_mfma_f32_16x16x32_bf16 v[32:35], v[132:135], v[160:163], v[32:35]
v_mfma_f32_16x16x32_bf16 v[48:51], v[136:139], v[160:163], v[48:51]
ds_read_b128 v[160:163], v5 offset:6144
s_waitcnt lgkmcnt(3)
v_mfma_f32_16x16x32_bf16 v[20:23], v[128:131], v[164:167], v[20:23]
v_mfma_f32_16x16x32_bf16 v[36:39], v[132:135], v[164:167], v[36:39]
v_mfma_f32_16x16x32_bf16 v[52:55], v[136:139], v[164:167], v[52:55]
ds_read_b128 v[164:167], v5 offset:7168
v_add_u32 v5, 8192, v5
s_waitcnt vmcnt(6) lgkmcnt(3)
v_mfma_f32_16x16x32_bf16 v[8:11], v[140:143], v[152:155], v[8:11]
v_mfma_f32_16x16x32_bf16 v[24:27], v[144:147], v[152:155], v[24:27]
v_mfma_f32_16x16x32_bf16 v[40:43], v[148:151], v[152:155], v[40:43]
ds_read_b128 v[152:155], v5 offset:0
s_waitcnt lgkmcnt(3)
v_mfma_f32_16x16x32_bf16 v[12:15], v[140:143], v[156:159], v[12:15]
v_mfma_f32_16x16x32_bf16 v[28:31], v[144:147], v[156:159], v[28:31]
v_mfma_f32_16x16x32_bf16 v[44:47], v[148:151], v[156:159], v[44:47]
ds_read_b128 v[156:159], v5 offset:1024
s_waitcnt lgkmcnt(3)
v_mfma_f32_16x16x32_bf16 v[16:19], v[140:143], v[160:163], v[16:19]
v_mfma_f32_16x16x32_bf16 v[32:35], v[144:147], v[160:163], v[32:35]
v_mfma_f32_16x16x32_bf16 v[48:51], v[148:151], v[160:163], v[48:51]
ds_read_b128 v[160:163], v5 offset:2048
s_waitcnt lgkmcnt(3)
v_mfma_f32_16x16x32_bf16 v[20:23], v[140:143], v[164:167], v[20:23]
v_mfma_f32_16x16x32_bf16 v[36:39], v[144:147], v[164:167], v[36:39]
v_mfma_f32_16x16x32_bf16 v[52:55], v[148:151], v[164:167], v[52:55]
ds_read_b128 v[164:167], v5 offset:3072
s_waitcnt vmcnt(3) lgkmcnt(3)
v_mfma_f32_16x16x32_bf16 v[8:11], v[104:107], v[152:155], v[8:11]
v_mfma_f32_16x16x32_bf16 v[24:27], v[108:111], v[152:155], v[24:27]
v_mfma_f32_16x16x32_bf16 v[40:43], v[112:115], v[152:155], v[40:43]
ds_read_b128 v[152:155], v5 offset:4096
s_waitcnt lgkmcnt(3)
v_mfma_f32_16x16x32_bf16 v[12:15], v[104:107], v[156:159], v[12:15]
v_mfma_f32_16x16x32_bf16 v[28:31], v[108:111], v[156:159], v[28:31]
v_mfma_f32_16x16x32_bf16 v[44:47], v[112:115], v[156:159], v[44:47]
ds_read_b128 v[156:159], v5 offset:5120
s_waitcnt lgkmcnt(3)
v_mfma_f32_16x16x32_bf16 v[16:19], v[104:107], v[160:163], v[16:19]
v_mfma_f32_16x16x32_bf16 v[32:35], v[108:111], v[160:163], v[32:35]
v_mfma_f32_16x16x32_bf16 v[48:51], v[112:115], v[160:163], v[48:51]
ds_read_b128 v[160:163], v5 offset:6144
s_waitcnt lgkmcnt(3)
v_mfma_f32_16x16x32_bf16 v[20:23], v[104:107], v[164:167], v[20:23]
v_mfma_f32_16x16x32_bf16 v[36:39], v[108:111], v[164:167], v[36:39]
v_mfma_f32_16x16x32_bf16 v[52:55], v[112:115], v[164:167], v[52:55]
ds_read_b128 v[164:167], v5 offset:7168
s_waitcnt vmcnt(0) lgkmcnt(3)
v_mfma_f32_16x16x32_bf16 v[8:11], v[116:119], v[152:155], v[8:11]
v_mfma_f32_16x16x32_bf16 v[24:27], v[120:123], v[152:155], v[24:27]
v_mfma_f32_16x16x32_bf16 v[40:43], v[124:127], v[152:155], v[40:43]
s_waitcnt lgkmcnt(2)
v_mfma_f32_16x16x32_bf16 v[12:15], v[116:119], v[156:159], v[12:15]
v_mfma_f32_16x16x32_bf16 v[28:31], v[120:123], v[156:159], v[28:31]
v_mfma_f32_16x16x32_bf16 v[44:47], v[124:127], v[156:159], v[44:47]
s_waitcnt lgkmcnt(1)
v_mfma_f32_16x16x32_bf16 v[16:19], v[116:119], v[160:163], v[16:19]
v_mfma_f32_16x16x32_bf16 v[32:35], v[120:123], v[160:163], v[32:35]
v_mfma_f32_16x16x32_bf16 v[48:51], v[124:127], v[160:163], v[48:51]
s_waitcnt lgkmcnt(0)
v_mfma_f32_16x16x32_bf16 v[20:23], v[116:119], v[164:167], v[20:23]
v_mfma_f32_16x16x32_bf16 v[36:39], v[120:123], v[164:167], v[36:39]
v_mfma_f32_16x16x32_bf16 v[52:55], v[124:127], v[164:167], v[52:55]
s_setprio 0
s_mul_i32 s28, s23, 2359296
s_mul_i32 s29, s24, 73728
s_add_u32 s28, s28, s29
s_mul_i32 s29, s22, 6144
s_add_u32 s28, s28, s29
s_lshr_b32 s25, s22, 1
s_and_b32 s25, s25, 1
s_lshr_b32 s26, s23, 2
s_cmp_eq_u32 s25, s26
s_cselect_b32 s25, 1, 0
s_lshr_b32 s26, s23, 1
s_and_b32 s26, s26, 1
s_xor_b32 s27, s26, 1
s_and_b32 s27, s27, s25
s_and_b32 s26, s26, s25
s_and_b32 s29, s23, 1
s_cmp_eq_u32 s29, 0
s_cselect_b32 s56, -1, 0
s_cselect_b32 s57, 0, -1
s_not_b64 s[58:59], s[56:57]
s_lshr_b32 s29, s22, 2
s_mul_i32 s29, s29, 3072
s_and_b32 s30, s22, 1
s_mul_i32 s30, s30, 1536
s_add_u32 s29, s29, s30
s_add_u32 s29, s29, 20480
v_and_b32 v6, 31, v1
v_lshlrev_b32 v6, 4, v6
v_add_u32 v6, s29, v6
v_cvt_pk_bf16_f32 v104, v8, v9
v_cvt_pk_bf16_f32 v105, v10, v11
v_cvt_pk_bf16_f32 v106, v12, v13
v_cvt_pk_bf16_f32 v107, v14, v15
s_cmp_eq_u32 s27, 0
s_cbranch_scc1 k5_po0a
s_mov_b64 exec, s[56:57]
ds_write_b128 v6, v[104:107] offset:0
s_mov_b64 exec, s[58:59]
buffer_store_dwordx4 v[104:107], v4, s[44:47], s28 offen offset:0 sc0 sc1
s_mov_b64 exec, -1
s_branch k5_po0b
k5_po0a:
buffer_store_dwordx4 v[104:107], v4, s[44:47], s28 offen offset:0 sc0 sc1
k5_po0b:
v_cvt_pk_bf16_f32 v108, v16, v17
v_cvt_pk_bf16_f32 v109, v18, v19
v_cvt_pk_bf16_f32 v110, v20, v21
v_cvt_pk_bf16_f32 v111, v22, v23
s_cmp_eq_u32 s26, 0
s_cbranch_scc1 k5_po1a
s_mov_b64 exec, s[56:57]
ds_write_b128 v6, v[108:111] offset:0
s_mov_b64 exec, s[58:59]
buffer_store_dwordx4 v[108:111], v4, s[44:47], s28 offen offset:1024 sc0 sc1
s_mov_b64 exec, -1
s_branch k5_po1b
k5_po1a:
buffer_store_dwordx4 v[108:111], v4, s[44:47], s28 offen offset:1024 sc0 sc1
k5_po1b:
v_cvt_pk_bf16_f32 v112, v24, v25
v_cvt_pk_bf16_f32 v113, v26, v27
v_cvt_pk_bf16_f32 v114, v28, v29
v_cvt_pk_bf16_f32 v115, v30, v31
s_cmp_eq_u32 s27, 0
s_cbranch_scc1 k5_po2a
s_mov_b64 exec, s[56:57]
ds_write_b128 v6, v[112:115] offset:512
s_mov_b64 exec, s[58:59]
buffer_store_dwordx4 v[112:115], v4, s[44:47], s28 offen offset:2048 sc0 sc1
s_mov_b64 exec, -1
s_branch k5_po2b
k5_po2a:
buffer_store_dwordx4 v[112:115], v4, s[44:47], s28 offen offset:2048 sc0 sc1
k5_po2b:
v_cvt_pk_bf16_f32 v116, v32, v33
v_cvt_pk_bf16_f32 v117, v34, v35
v_cvt_pk_bf16_f32 v118, v36, v37
v_cvt_pk_bf16_f32 v119, v38, v39
s_cmp_eq_u32 s26, 0
s_cbranch_scc1 k5_po3a
s_mov_b64 exec, s[56:57]
ds_write_b128 v6, v[116:119] offset:512
s_mov_b64 exec, s[58:59]
buffer_store_dwordx4 v[116:119], v4, s[44:47], s28 offen offset:3072 sc0 sc1
s_mov_b64 exec, -1
s_branch k5_po3b
k5_po3a:
buffer_store_dwordx4 v[116:119], v4, s[44:47], s28 offen offset:3072 sc0 sc1
k5_po3b:
v_cvt_pk_bf16_f32 v120, v40, v41
v_cvt_pk_bf16_f32 v121, v42, v43
v_cvt_pk_bf16_f32 v122, v44, v45
v_cvt_pk_bf16_f32 v123, v46, v47
s_cmp_eq_u32 s27, 0
s_cbranch_scc1 k5_po4a
s_mov_b64 exec, s[56:57]
ds_write_b128 v6, v[120:123] offset:1024
s_mov_b64 exec, s[58:59]
buffer_store_dwordx4 v[120:123], v7, s[44:47], s28 offen offset:0 sc0 sc1
s_mov_b64 exec, -1
s_branch k5_po4b
k5_po4a:
buffer_store_dwordx4 v[120:123], v7, s[44:47], s28 offen offset:0 sc0 sc1
k5_po4b:
v_cvt_pk_bf16_f32 v124, v48, v49
v_cvt_pk_bf16_f32 v125, v50, v51
v_cvt_pk_bf16_f32 v126, v52, v53
v_cvt_pk_bf16_f32 v127, v54, v55
s_cmp_eq_u32 s26, 0
s_cbranch_scc1 k5_po5a
s_mov_b64 exec, s[56:57]
ds_write_b128 v6, v[124:127] offset:1024
s_mov_b64 exec, s[58:59]
buffer_store_dwordx4 v[124:127], v7, s[44:47], s28 offen offset:1024 sc0 sc1
s_mov_b64 exec, -1
s_branch k5_po5b
k5_po5a:
buffer_store_dwordx4 v[124:127], v7, s[44:47], s28 offen offset:1024 sc0 sc1
k5_po5b:
s_load_dwordx2 s[4:5], s[0:1], 72
s_waitcnt vmcnt(0) lgkmcnt(0)
s_add_u32 s52, s20, 0x3b00000
s_addc_u32 s53, s21, 0
s_mov_b32 s54, 0x20000
s_mov_b32 s55, 0x00020000
s_add_u32 s8, s20, 0x2200000
s_addc_u32 s9, s21, 0
s_mov_b32 s10, 0x1200000
s_mov_b32 s11, 0x00020000
s_add_u32 s12, s20, 0x3700000
s_addc_u32 s13, s21, 0
s_mov_b32 s14, 0x240000
s_mov_b32 s15, 0x00020000
s_add_u32 s16, s20, 0x2d00
s_addc_u32 s17, s21, 0
s_mov_b32 s18, 0x900
s_mov_b32 s19, 0x00020000
s_mov_b32 s48, s4
s_mov_b32 s49, s5
s_mov_b32 s50, 0x240000
s_mov_b32 s51, 0x00020000
s_lshr_b32 s30, s22, 2
s_lshl_b32 s42, s30, 2
s_add_u32 s57, s42, 147472
v_mov_b32 v25, s57
v_mov_b32 v7, 1
s_mov_b64 exec, 1
ds_add_rtn_u32 v8, v25, v7
s_waitcnt lgkmcnt(0)
v_readfirstlane_b32 s26, v8
s_mul_i32 s28, s24, 3
s_add_u32 s28, s28, s30
s_add_u32 s28, s28, 160
s_lshl_b32 s28, s28, 9
v_mov_b32 v6, s28
s_cmp_lg_u32 s26, 3
s_cbranch_scc1 k5_nosig
buffer_atomic_add v7, v6, s[52:55], 0 offen sc1
k5_nosig:
s_mov_b64 exec, -1
v_mov_b32 v23, s28
s_and_b32 s29, s22, 3
s_cmp_eq_u32 s29, 3
s_cbranch_scc1 k5_noload
v_mov_b32 v5, s30
s_lshl_b32 s27, s30, 8
v_subrev_u32 v6, s27, v0
s_lshl_b32 s27, s30, 3
s_add_u32 s27, s27, s23
v_mov_b32 v7, s27
v_and_b32 v8, 1, v7
v_lshrrev_b32 v7, 1, v7
v_and_b32 v9, 1, v7
v_lshrrev_b32 v7, 1, v7
v_mul_u32_u24 v10, 10923, v6
v_lshrrev_b32 v10, 16, v10
v_mul_u32_u24 v11, 6, v10
v_sub_u32 v11, v6, v11
v_mul_u32_u24 v12, 12, v7
v_mul_u32_u24 v13, 6, v8
v_add3_u32 v12, v12, v13, v11
v_lshl_add_u32 v13, v9, 5, v10
v_lshrrev_b32 v14, 2, v12
v_lshlrev_b32 v14, 12, v14
v_and_b32 v15, 3, v12
v_lshl_add_u32 v14, v15, 8, v14
v_lshrrev_b32 v15, 4, v13
v_lshl_add_u32 v14, v15, 10, v14
v_and_b32 v15, 15, v13
v_lshl_add_u32 v14, v15, 4, v14
s_mul_i32 s27, s24, 73728
buffer_load_dwordx4 v[48:51], v14, s[12:15], s27 offen sc1
v_lshlrev_b32 v15, 5, v12
buffer_load_dwordx4 v[52:55], v15, s[16:19], 0 offen
buffer_load_dwordx4 v[56:59], v15, s[16:19], 0 offen offset:16
v_mul_u32_u24 v13, 1152, v13
v_lshl_add_u32 v13, v12, 4, v13
v_lshrrev_b32 v15, 5, v6
v_cmp_le_u32 vcc, 3, v15
s_nop 1
v_cndmask_b32 v16, 0, 1, vcc
v_mul_u32_u24 v17, 3, v16
v_sub_u32 v17, v15, v17
v_and_b32 v18, 31, v6
v_lshl_add_u32 v19, v7, 1, v16
v_mul_u32_u24 v19, 6144, v19
v_lshl_add_u32 v20, v17, 1, v9
v_lshl_add_u32 v19, v20, 10, v19
v_lshl_add_u32 v20, v8, 5, v18
v_lshl_add_u32 v19, v20, 4, v19
v_mul_u32_u24 v20, 6656, v5
v_and_b32 v21, 15, v18
v_mul_u32_u24 v21, 208, v21
v_add_u32 v20, v20, v21
v_lshrrev_b32 v21, 4, v18
v_mul_u32_u24 v21, 96, v21
v_add_u32 v20, v20, v21
v_lshl_add_u32 v20, v15, 2, v20
v_mul_u32_u24 v21, 6656, v5
v_mul_u32_u24 v22, 208, v10
v_add_u32 v21, v21, v22
v_lshl_add_u32 v21, v11, 5, v21
k5_noload:
s_cmp_lg_u32 s26, 3
s_cbranch_scc1 k5_waitgo
s_mov_b32 s29, 20000
k5_poll:
buffer_load_dword v24, v23, s[52:55], 0 offen sc0 sc1
s_waitcnt vmcnt(0)
v_readfirstlane_b32 s25, v24
s_sub_u32 s29, s29, 1
s_cmp_eq_u32 s29, 0
s_cbranch_scc1 k5_release
s_cmp_ge_u32 s25, 8
s_cbranch_scc0 k5_poll
k5_release:
v_add_u32 v24, 12, v25
v_mov_b32 v26, 1
ds_write_b32 v24, v26
s_waitcnt lgkmcnt(0)
k5_waitgo:
s_and_b32 s29, s22, 3
s_cmp_eq_u32 s29, 3
s_cbranch_scc1 k5_exit
k5_go:
ds_read_b32 v24, v25 offset:12
s_waitcnt lgkmcnt(0)
v_readfirstlane_b32 s25, v24
s_nop 0
s_cmp_eq_u32 s25, 0
s_cbranch_scc1 k5_go
s_mov_b32 s40, 0x00003f80
s_mov_b32 s41, 0x3f800000
s_add_u32 s28, s23, 1
s_and_b32 s28, s28, 7
s_mul_i32 s28, s28, 2359296
s_mul_i32 s27, s24, 73728
s_add_u32 s27, s27, s28
buffer_load_dwordx4 v[64:67], v19, s[8:11], s27 offen sc1
s_add_u32 s28, s23, 2
s_and_b32 s28, s28, 7
s_mul_i32 s28, s28, 2359296
s_mul_i32 s27, s24, 73728
s_add_u32 s27, s27, s28
buffer_load_dwordx4 v[68:71], v19, s[8:11], s27 offen sc1
s_add_u32 s28, s23, 3
s_and_b32 s28, s28, 7
s_mul_i32 s28, s28, 2359296
s_mul_i32 s27, s24, 73728
s_add_u32 s27, s27, s28
buffer_load_dwordx4 v[72:75], v19, s[8:11], s27 offen sc1
s_add_u32 s28, s23, 4
s_and_b32 s28, s28, 7
s_mul_i32 s28, s28, 2359296
s_mul_i32 s27, s24, 73728
s_add_u32 s27, s27, s28
buffer_load_dwordx4 v[76:79], v19, s[8:11], s27 offen sc1
s_add_u32 s28, s23, 5
s_and_b32 s28, s28, 7
s_mul_i32 s28, s28, 2359296
s_mul_i32 s27, s24, 73728
s_add_u32 s27, s27, s28
buffer_load_dwordx4 v[80:83], v19, s[8:11], s27 offen sc1
s_add_u32 s28, s23, 6
s_and_b32 s28, s28, 7
s_mul_i32 s28, s28, 2359296
s_mul_i32 s27, s24, 73728
s_add_u32 s27, s27, s28
buffer_load_dwordx4 v[84:87], v19, s[8:11], s27 offen sc1
s_add_u32 s28, s23, 7
s_and_b32 s28, s28, 7
s_mul_i32 s28, s28, 2359296
s_mul_i32 s27, s24, 73728
s_add_u32 s27, s27, s28
buffer_load_dwordx4 v[88:91], v19, s[8:11], s27 offen sc1
s_mul_i32 s27, s30, 3072
s_add_u32 s27, s27, 20480
v_lshlrev_b32 v9, 4, v6
v_add_u32 v9, s27, v9
ds_read_b128 v[92:95], v9
s_waitcnt vmcnt(6)
v_dot2_f32_bf16 v96, v64, s40, 0
v_dot2_f32_bf16 v97, v64, s41, 0
v_dot2_f32_bf16 v98, v65, s40, 0
v_dot2_f32_bf16 v99, v65, s41, 0
v_dot2_f32_bf16 v100, v66, s40, 0
v_dot2_f32_bf16 v101, v66, s41, 0
v_dot2_f32_bf16 v102, v67, s40, 0
v_dot2_f32_bf16 v103, v67, s41, 0
s_waitcnt vmcnt(5)
v_dot2_f32_bf16 v96, v68, s40, v96
v_dot2_f32_bf16 v97, v68, s41, v97
v_dot2_f32_bf16 v98, v69, s40, v98
v_dot2_f32_bf16 v99, v69, s41, v99
v_dot2_f32_bf16 v100, v70, s40, v100
v_dot2_f32_bf16 v101, v70, s41, v101
v_dot2_f32_bf16 v102, v71, s40, v102
v_dot2_f32_bf16 v103, v71, s41, v103
s_waitcnt vmcnt(4)
v_dot2_f32_bf16 v96, v72, s40, v96
v_dot2_f32_bf16 v97, v72, s41, v97
v_dot2_f32_bf16 v98, v73, s40, v98
v_dot2_f32_bf16 v99, v73, s41, v99
v_dot2_f32_bf16 v100, v74, s40, v100
v_dot2_f32_bf16 v101, v74, s41, v101
v_dot2_f32_bf16 v102, v75, s40, v102
v_dot2_f32_bf16 v103, v75, s41, v103
s_waitcnt vmcnt(3)
v_dot2_f32_bf16 v96, v76, s40, v96
v_dot2_f32_bf16 v97, v76, s41, v97
v_dot2_f32_bf16 v98, v77, s40, v98
v_dot2_f32_bf16 v99, v77, s41, v99
v_dot2_f32_bf16 v100, v78, s40, v100
v_dot2_f32_bf16 v101, v78, s41, v101
v_dot2_f32_bf16 v102, v79, s40, v102
v_dot2_f32_bf16 v103, v79, s41, v103
s_waitcnt vmcnt(2)
v_dot2_f32_bf16 v96, v80, s40, v96
v_dot2_f32_bf16 v97, v80, s41, v97
v_dot2_f32_bf16 v98, v81, s40, v98
v_dot2_f32_bf16 v99, v81, s41, v99
v_dot2_f32_bf16 v100, v82, s40, v100
v_dot2_f32_bf16 v101, v82, s41, v101
v_dot2_f32_bf16 v102, v83, s40, v102
v_dot2_f32_bf16 v103, v83, s41, v103
s_waitcnt vmcnt(1)
v_dot2_f32_bf16 v96, v84, s40, v96
v_dot2_f32_bf16 v97, v84, s41, v97
v_dot2_f32_bf16 v98, v85, s40, v98
v_dot2_f32_bf16 v99, v85, s41, v99
v_dot2_f32_bf16 v100, v86, s40, v100
v_dot2_f32_bf16 v101, v86, s41, v101
v_dot2_f32_bf16 v102, v87, s40, v102
v_dot2_f32_bf16 v103, v87, s41, v103
s_waitcnt vmcnt(0)
v_dot2_f32_bf16 v96, v88, s40, v96
v_dot2_f32_bf16 v97, v88, s41, v97
v_dot2_f32_bf16 v98, v89, s40, v98
v_dot2_f32_bf16 v99, v89, s41, v99
v_dot2_f32_bf16 v100, v90, s40, v100
v_dot2_f32_bf16 v101, v90, s41, v101
v_dot2_f32_bf16 v102, v91, s40, v102
v_dot2_f32_bf16 v103, v91, s41, v103
s_waitcnt lgkmcnt(0)
v_dot2_f32_bf16 v96, v92, s40, v96
v_dot2_f32_bf16 v97, v92, s41, v97
v_dot2_f32_bf16 v98, v93, s40, v98
v_dot2_f32_bf16 v99, v93, s41, v99
v_dot2_f32_bf16 v100, v94, s40, v100
v_dot2_f32_bf16 v101, v94, s41, v101
v_dot2_f32_bf16 v102, v95, s40, v102
v_dot2_f32_bf16 v103, v95, s41, v103
ds_write_b32 v20, v96 offset:0
ds_write_b32 v20, v97 offset:24
ds_write_b32 v20, v98 offset:48
ds_write_b32 v20, v99 offset:72
ds_write_b32 v20, v100 offset:3328
ds_write_b32 v20, v101 offset:3352
ds_write_b32 v20, v102 offset:3376
ds_write_b32 v20, v103 offset:3400
s_waitcnt lgkmcnt(0)
v_mov_b32 v26, 1
s_mov_b64 exec, 1
ds_add_u32 v25, v26 offset:24
s_mov_b64 exec, -1
k5_sc:
ds_read_b32 v24, v25 offset:24
s_waitcnt lgkmcnt(0)
v_readfirstlane_b32 s25, v24
s_nop 0
s_cmp_ge_u32 s25, 3
s_cbranch_scc0 k5_sc
ds_read_b128 v[96:99], v21 offset:0
ds_read_b128 v[100:103], v21 offset:16
s_waitcnt lgkmcnt(0)
v_lshlrev_b32 v9, 16, v48
v_and_b32 v10, 0xffff0000, v48
v_fmac_f32 v9, v52, v96
v_fmac_f32 v10, v53, v97
v_cvt_pk_bf16_f32 v48, v9, v10
v_lshlrev_b32 v9, 16, v49
v_and_b32 v10, 0xffff0000, v49
v_fmac_f32 v9, v54, v98
v_fmac_f32 v10, v55, v99
v_cvt_pk_bf16_f32 v49, v9, v10
v_lshlrev_b32 v9, 16, v50
v_and_b32 v10, 0xffff0000, v50
v_fmac_f32 v9, v56, v100
v_fmac_f32 v10, v57, v101
v_cvt_pk_bf16_f32 v50, v9, v10
v_lshlrev_b32 v9, 16, v51
v_and_b32 v10, 0xffff0000, v51
v_fmac_f32 v9, v58, v102
v_fmac_f32 v10, v59, v103
v_cvt_pk_bf16_f32 v51, v9, v10
s_mul_i32 s27, s24, 73728
buffer_store_dwordx4 v[48:51], v13, s[48:51], s27 offen
k5_exit:
k3_exit:
s_endpgm
.section .rodata,"a"
.p2align 6
.amdhsa_kernel k3_attn_kernel
  .amdhsa_next_free_vgpr 168
  .amdhsa_next_free_sgpr 64
  .amdhsa_accum_offset 168
  .amdhsa_group_segment_fixed_size 0
  .amdhsa_kernarg_size 96
  .amdhsa_user_sgpr_count 2
  .amdhsa_user_sgpr_kernarg_segment_ptr 1
  .amdhsa_system_sgpr_workgroup_id_x 1
  .amdhsa_float_denorm_mode_32 3
.end_amdhsa_kernel
```
